```python
import torch

def _softmax(x, axis=-1):
    return torch.softmax(x, dim=axis)

def _gelu(x):
    return torch.nn.functional.gelu(x, approximate='tanh')

def _silu(x):
    return torch.nn.functional.silu(x)

def _sigmoid(x):
    return torch.sigmoid(x)

def _layernorm(x, axis=-1, eps=1e-05):
    m = x.mean(dim=axis, keepdim=True)
    v = x.var(dim=axis, keepdim=True, unbiased=False)
    return (x - m) / torch.sqrt(v + eps)

def _scatter_add(tgt, idx, src, axis=0):
    return tgt.clone().index_add_(axis, idx, src)

def _segment_sum(src, seg, n):
    out = torch.zeros((n,) + src.shape[1:], dtype=src.dtype)
    return out.index_add_(0, seg, src)

def _pad(x, pw):
    flat = tuple((v for pair in reversed(pw) for v in pair))
    return torch.nn.functional.pad(x, flat)
kernel_name = 'adaLN_cond__sliding_block_cached__geglu_ffn__decode'

def setup_inputs():

    _w = lambda a: (lambda t: t.to(torch.bfloat16) if t.is_floating_point() else t)(torch.as_tensor(a))

    def _A_setup():
        B, Sq, D = (1, 1, 576)
        Hq, Hkv, Sk, Dh = (32, 16, 65536, 128)
        assert Hq % Hkv == 0, (Hq, Hkv)
        return {'x': _w((lambda *s: torch.randn(*s, dtype=torch.bfloat16) * 0.05)(B, Sq, D)), 'k_cache': _w((lambda *s: torch.randn(*s, dtype=torch.bfloat16) * 3.2)(B, Hkv, Sk, Dh)), 'v_cache': _w((lambda *s: torch.randn(*s, dtype=torch.bfloat16) * 0.4)(B, Hkv, Sk, Dh)), 'wq': _w((lambda *s: torch.randn(*s, dtype=torch.bfloat16) * 3.2)(D, Hq * Dh) * D ** (-0.5)), 'wo': _w((lambda *s: torch.randn(*s, dtype=torch.bfloat16) * 0.4)(Hq * Dh, D) * (Hq * Dh) ** (-0.5))}
    _A_in = _A_setup()

    def _B_setup():
        B, S, D, F = (1, 1, 576, 4608)
        return {'x': _w((lambda *s: torch.randn(*s, dtype=torch.bfloat16) * 0.05)(B, S, D)), 'w_gate': _w((lambda *s: torch.randn(*s, dtype=torch.bfloat16) * 0.05)(D, F)), 'w_up': _w((lambda *s: torch.randn(*s, dtype=torch.bfloat16) * 0.05)(D, F)), 'w_down': _w((lambda *s: torch.randn(*s, dtype=torch.bfloat16) * 0.05)(F, D))}
    _B_in = _B_setup()
    return {'A_x': _A_in['x'], 'A_k_cache': _A_in['k_cache'], 'A_v_cache': _A_in['v_cache'], 'A_wq': _A_in['wq'], 'A_wo': _A_in['wo'], 'B_x': _B_in['x'], 'B_w_gate': _B_in['w_gate'], 'B_w_up': _B_in['w_up'], 'B_w_down': _B_in['w_down'], 'c': _w((lambda *s: torch.randn(*s, dtype=torch.bfloat16) * 0.1)(1, 576) * 8.0), 'w_mod': _w((lambda *s: torch.randn(*s, dtype=torch.bfloat16) * 0.1)(576, 6 * 576) * 576 ** (-0.5) * 8.0)}

def reference(A_x, A_k_cache, A_v_cache, A_wq, A_wo, B_x, B_w_gate, B_w_up, B_w_down, c, w_mod):

    def _A_ref(x, k_cache, v_cache, wq, wo):
        B, Sq, D = x.shape
        Hq, Dh = (32, 128)
        Hkv, Sk = (k_cache.shape[1], k_cache.shape[2])
        W = min(4096, max(256, Sk // 4))
        rep = Hq // Hkv
        q = (lambda x, *d: x.permute(*d))((x @ wq).reshape(B, Sq, Hq, Dh), 0, 2, 1, 3)
        k = (lambda x, n, axis: torch.repeat_interleave(x, n, dim=axis))(k_cache[:, :, Sk - W:, :], rep, axis=1)
        v = (lambda x, n, axis: torch.repeat_interleave(x, n, dim=axis))(v_cache[:, :, Sk - W:, :], rep, axis=1)
        scores = torch.einsum('bhqd,bhkd->bhqk', q, k) * Dh ** (-0.5)
        p = _softmax(scores, axis=-1)
        o = torch.einsum('bhqk,bhkd->bhqd', p, v)
        return (lambda x, *d: x.permute(*d))(o, 0, 2, 1, 3).reshape(B, Sq, Hq * Dh) @ wo

    def _B_ref(x, w_gate, w_up, w_down):
        return _gelu(x @ w_gate) * (x @ w_up) @ w_down
    x = A_x
    mod = (_silu(c) @ w_mod).reshape(c.shape[0], 6, 1, -1)
    sa, ca, ga, sb, cb, gb = (mod[:, 0].clone(), mod[:, 1].clone(), mod[:, 2].clone(), mod[:, 3].clone(), mod[:, 4].clone(), mod[:, 5].clone())
    h = _layernorm(x, axis=-1) * (1 + ca) + sa
    x = x + ga * _A_ref(h, A_k_cache, A_v_cache, A_wq, A_wo)
    h = _layernorm(x, axis=-1) * (1 + cb) + sb
    x = x + gb * _B_ref(h, B_w_gate, B_w_up, B_w_down)
    return x
```

```asm
; @launch grid=(256,1,1) block=(1024,1,1) lds=35328
.amdgcn_target "amdgcn-amd-amdhsa--gfx950"
.text
.globl adaLN_cond__sliding_block_cached__geglu_ffn__decode_kernel
.p2align 8
.type adaLN_cond__sliding_block_cached__geglu_ffn__decode_kernel,@function
adaLN_cond__sliding_block_cached__geglu_ffn__decode_kernel:
    s_cmp_ge_u32 s2, 256
    s_cbranch_scc1 L_end
    s_load_dwordx16 s[8:23], s[0:1], 0
    s_load_dwordx8 s[24:31], s[0:1], 64
    s_load_dwordx4 s[32:35], s[0:1], 96
    s_cmp_ge_u32 s2, 16
    s_cbranch_scc1 L_nopf0
    v_lshrrev_b32 v4, 6, v0
    v_cmp_ne_u32 vcc, 10, v4
    s_nop 4
    s_cbranch_vccnz L_nopf0
    v_and_b32 v1, 63, v0
    s_getpc_b64 s[52:53]
L_pc0:
    s_sub_u32 s52, s52, L_pc0-adaLN_cond__sliding_block_cached__geglu_ffn__decode_kernel
    s_subb_u32 s53, s53, 0
    v_lshlrev_b32 v4, 7, v1
    v_cmp_gt_u32 vcc, L_codeend-adaLN_cond__sliding_block_cached__geglu_ffn__decode_kernel, v4
    s_nop 2
    s_and_saveexec_b64 s[62:63], vcc
    global_load_dword v124, v4, s[52:53]
    s_mov_b64 exec, s[62:63]
    v_add_u32 v4, 0x2000, v4
    v_cmp_gt_u32 vcc, L_codeend-adaLN_cond__sliding_block_cached__geglu_ffn__decode_kernel, v4
    s_nop 2
    s_and_saveexec_b64 s[62:63], vcc
    global_load_dword v125, v4, s[52:53]
    s_mov_b64 exec, s[62:63]
    v_add_u32 v4, 0x2000, v4
    v_cmp_gt_u32 vcc, L_codeend-adaLN_cond__sliding_block_cached__geglu_ffn__decode_kernel, v4
    s_nop 2
    s_and_saveexec_b64 s[62:63], vcc
    global_load_dword v126, v4, s[52:53]
    s_mov_b64 exec, s[62:63]
    v_add_u32 v4, 0x2000, v4
    v_cmp_gt_u32 vcc, L_codeend-adaLN_cond__sliding_block_cached__geglu_ffn__decode_kernel, v4
    s_nop 2
    s_and_saveexec_b64 s[62:63], vcc
    global_load_dword v127, v4, s[52:53]
    s_mov_b64 exec, s[62:63]
    v_add_u32 v4, 0x2000, v4
L_nopf0:
    v_lshrrev_b32 v4, 6, v0
    v_and_b32 v1, 63, v0
    v_and_b32 v2, 15, v1
    v_readfirstlane_b32 s3, v4
    v_lshrrev_b32 v3, 4, v1
    s_and_b32 s4, s2, 7
    s_lshl_b32 s4, s4, 1
    s_bfe_u32 s5, s2, 0x10003
    s_add_u32 s4, s4, s5
    s_lshr_b32 s5, s2, 4
    s_cmp_lg_u32 s3, 0
    s_cbranch_scc1 L_nozero
    v_lshlrev_b32 v4, 2, v1
    v_mov_b32 v5, 0
    ds_write_b32 v4, v5
    ds_write_b32 v4, v5 offset:256
    ds_write_b32 v4, v5 offset:4352
L_nozero:
    s_waitcnt lgkmcnt(0)
    s_load_dwordx2 s[6:7], s[34:35], 0
    s_mov_b32 s44, s34
    s_mov_b32 s45, s35
    s_mov_b32 s46, 1073741824
    s_mov_b32 s47, 0x20000
    s_cmp_lt_u32 s5, 3
    s_cbranch_scc1 L_classM
    s_cmp_lt_u32 s5, 7
    s_cbranch_scc1 L_classQ
    s_cmp_eq_u32 s3, 0
    s_cbranch_scc1 L_kvF0
    s_cmp_le_u32 s3, 4
    s_cbranch_scc1 L_gu
    s_cmp_ge_u32 s3, 5
    s_cbranch_scc1 L_kvF
    s_branch L_idle
L_classQ:
    s_cmp_ge_u32 s3, 14
    s_cbranch_scc1 L_kvQ
    s_cmp_eq_u32 s3, 0
    s_cbranch_scc1 L_commA
    s_cmp_le_u32 s3, 6
    s_cbranch_scc1 L_wq
    s_cmp_le_u32 s3, 9
    s_cbranch_scc1 L_woQ
    s_branch L_idle
L_classM:
    s_cmp_ge_u32 s3, 12
    s_cbranch_scc1 L_kvM
    s_cmp_eq_u32 s3, 0
    s_cbranch_scc1 L_commA
    s_cmp_le_u32 s3, 6
    s_cbranch_scc1 L_mod
    s_cmp_le_u32 s3, 9
    s_cbranch_scc1 L_woM
L_idle:
    s_barrier
    s_waitcnt vmcnt(0)
    s_branch L_end
L_mod:
    s_mov_b32 s54, s2
    s_cmp_ge_u32 s54, 36
    s_cbranch_scc1 L_mod_noA
    s_mov_b32 s36, s28
    s_mov_b32 s37, s29
    s_mov_b32 s38, 3981312
    s_mov_b32 s39, 0x20000
    s_mov_b32 s40, s26
    s_mov_b32 s41, s27
    s_mov_b32 s42, 1152
    s_mov_b32 s43, 0x20000
    s_sub_u32 s53, s3, 1
    v_lshlrev_b32 v4, 1, v1
    s_and_b32 s56, s54, 1
    s_mul_i32 s57, s56, 288
    s_mul_i32 s58, s53, 48
    s_add_u32 s57, s57, s58
    s_lshl_b32 s58, s57, 1
    buffer_load_ushort v16, v4, s[40:43], s58 offen
    v_lshrrev_b32 v13, 3, v2
    v_lshl_add_u32 v13, v13, 2, v3
    v_mul_u32_u24 v5, 6912, v13
    v_and_b32 v7, 7, v2
    v_lshl_add_u32 v5, v7, 4, v5
    s_lshr_b32 s55, s54, 1
    s_mul_i32 s58, s57, 6912
    s_lshl_b32 s59, s55, 7
    s_add_u32 s58, s58, s59
    buffer_load_dwordx4 v[32:35], v5, s[36:39], s58 offen nt
    s_add_u32 s58, s58, 55296
    buffer_load_dwordx4 v[36:39], v5, s[36:39], s58 offen nt
    s_add_u32 s58, s58, 55296
    buffer_load_dwordx4 v[40:43], v5, s[36:39], s58 offen nt
    s_add_u32 s58, s58, 55296
    buffer_load_dwordx4 v[44:47], v5, s[36:39], s58 offen nt
    s_add_u32 s58, s58, 55296
    buffer_load_dwordx4 v[48:51], v5, s[36:39], s58 offen nt
    s_add_u32 s58, s58, 55296
    buffer_load_dwordx4 v[52:55], v5, s[36:39], s58 offen nt
    s_barrier
    v_lshlrev_b32 v31, 2, v13
    s_lshl_b32 s67, s53, 10
    v_add_u32 v31, s67, v31
    v_lshlrev_b32 v30, 2, v1
    v_add_u32 v30, s67, v30
    s_mul_i32 s65, s56, 9216
    s_lshl_b32 s60, s55, 9
    s_add_u32 s65, s65, s60
    s_add_u32 s65, s65, 4096
    v_lshlrev_b32 v29, 5, v3
    v_add_u32 v29, v29, v2
    v_lshlrev_b32 v29, 3, v29
    v_and_b32 v6, 1, v2
    v_lshlrev_b32 v6, 4, v6
    v_mov_b32 v7, 0xffff
    v_lshlrev_b32 v7, v6, v7
    v_bfe_u32 v6, v2, 1, 2
    v_cmp_eq_u32 vcc, 0, v6
    s_nop 1
    v_cndmask_b32 v8, 0, v7, vcc
    v_cmp_eq_u32 vcc, 1, v6
    s_nop 1
    v_cndmask_b32 v9, 0, v7, vcc
    v_cmp_eq_u32 vcc, 2, v6
    s_nop 1
    v_cndmask_b32 v10, 0, v7, vcc
    v_cmp_eq_u32 vcc, 3, v6
    s_nop 1
    v_cndmask_b32 v11, 0, v7, vcc
    s_waitcnt lgkmcnt(0)
    s_add_u32 s6, s6, 0x7f4a7c15
    s_add_u32 s7, s7, 0x9e3779b9
    v_mov_b32 v61, s7
    v_mov_b32 v63, s7
    v_mov_b32 v65, s7
    v_mov_b32 v67, s7
    s_waitcnt vmcnt(6)
    s_mov_b32 s60, 0xbfb8aa3b
    v_lshlrev_b32 v16, 16, v16
    v_mul_f32 v19, s60, v16
    v_exp_f32 v19, v19
    s_nop 0
    v_add_f32 v19, 1.0, v19
    v_rcp_f32 v19, v19
    s_nop 0
    v_mul_f32 v16, v16, v19
    v_cvt_pk_bf16_f32 v16, v16, v16
    ds_write_b32 v30, v16 offset:16896
    ds_read_b32 v104, v31 offset:16896
    ds_read_b32 v105, v31 offset:16928
    ds_read_b32 v106, v31 offset:16960
    ds_read_b32 v107, v31 offset:16992
    ds_read_b32 v108, v31 offset:17024
    ds_read_b32 v109, v31 offset:17056
    s_waitcnt vmcnt(0) lgkmcnt(0)
    v_mov_b32 v7, 0
    v_mov_b32 v6, 1
    s_mov_b64 s[62:63], exec
    s_mov_b64 exec, 1
    ds_add_u32 v7, v6 offset:24
    s_mov_b64 exec, s[62:63]
    v_and_b32 v120, v104, v8
    v_and_b32 v121, v104, v9
    v_and_b32 v122, v104, v10
    v_and_b32 v123, v104, v11
    v_and_b32 v124, v105, v8
    v_and_b32 v125, v105, v9
    v_and_b32 v126, v105, v10
    v_and_b32 v127, v105, v11
    v_mfma_f32_16x16x32_bf16 v[116:119], v[32:35], v[120:123], 0
    v_and_b32 v120, v106, v8
    v_and_b32 v121, v106, v9
    v_and_b32 v122, v106, v10
    v_and_b32 v123, v106, v11
    v_mfma_f32_16x16x32_bf16 v[116:119], v[36:39], v[124:127], v[116:119]
    v_and_b32 v124, v107, v8
    v_and_b32 v125, v107, v9
    v_and_b32 v126, v107, v10
    v_and_b32 v127, v107, v11
    v_mfma_f32_16x16x32_bf16 v[116:119], v[40:43], v[120:123], v[116:119]
    v_and_b32 v120, v108, v8
    v_and_b32 v121, v108, v9
    v_and_b32 v122, v108, v10
    v_and_b32 v123, v108, v11
    v_mfma_f32_16x16x32_bf16 v[116:119], v[44:47], v[124:127], v[116:119]
    v_and_b32 v124, v109, v8
    v_and_b32 v125, v109, v9
    v_and_b32 v126, v109, v10
    v_and_b32 v127, v109, v11
    v_mfma_f32_16x16x32_bf16 v[116:119], v[48:51], v[120:123], v[116:119]
    s_nop 0
    v_mfma_f32_16x16x32_bf16 v[116:119], v[52:55], v[124:127], v[116:119]
    s_lshl_b32 s59, s53, 10
    v_lshlrev_b32 v16, 4, v1
    v_add_u32 v19, s59, v16
    s_nop 4
    ds_write_b128 v19, v[116:119] offset:4608
    v_mov_b32 v7, 0
    v_mov_b32 v6, 1
    s_mov_b64 s[62:63], exec
    s_mov_b64 exec, 1
    ds_add_rtn_u32 v6, v7, v6 offset:16
    s_waitcnt lgkmcnt(0)
    v_readfirstlane_b32 s60, v6
    s_mov_b64 exec, s[62:63]
    s_nop 1
    s_cmp_lg_u32 s60, 5
    s_cbranch_scc1 L_mod_fin
    ds_read_b128 v[32:35], v16 offset:4608
    ds_read_b128 v[36:39], v16 offset:5632
    ds_read_b128 v[40:43], v16 offset:6656
    ds_read_b128 v[44:47], v16 offset:7680
    ds_read_b128 v[48:51], v16 offset:8704
    ds_read_b128 v[52:55], v16 offset:9728
    s_waitcnt lgkmcnt(0)
    v_add_f32 v32, v32, v36
    v_add_f32 v33, v33, v37
    v_add_f32 v34, v34, v38
    v_add_f32 v35, v35, v39
    v_add_f32 v40, v40, v44
    v_add_f32 v41, v41, v45
    v_add_f32 v42, v42, v46
    v_add_f32 v43, v43, v47
    v_add_f32 v48, v48, v52
    v_add_f32 v49, v49, v53
    v_add_f32 v50, v50, v54
    v_add_f32 v51, v51, v55
    v_add_f32 v32, v32, v40
    v_add_f32 v33, v33, v41
    v_add_f32 v34, v34, v42
    v_add_f32 v35, v35, v43
    v_add_f32 v32, v32, v48
    v_add_f32 v33, v33, v49
    v_add_f32 v34, v34, v50
    v_add_f32 v35, v35, v51
    v_mov_b32 v36, v32
    v_mov_b32 v37, v33
    v_mov_b32 v38, v34
    v_mov_b32 v39, v35
    v_permlane32_swap_b32 v32, v36
    v_permlane32_swap_b32 v33, v37
    v_permlane32_swap_b32 v34, v38
    v_permlane32_swap_b32 v35, v39
    v_add_f32_dpp v32, v36, v32 row_shl:8 row_mask:0xf bank_mask:0xf
    v_add_f32_dpp v33, v37, v33 row_shl:8 row_mask:0xf bank_mask:0xf
    v_add_f32_dpp v34, v38, v34 row_shl:8 row_mask:0xf bank_mask:0xf
    v_add_f32_dpp v35, v39, v35 row_shl:8 row_mask:0xf bank_mask:0xf
    v_mov_b32 v60, v32
    v_mov_b32 v62, v33
    v_mov_b32 v64, v34
    v_mov_b32 v66, v35
    s_mov_b64 exec, 0x00ff00ff
    buffer_store_dwordx2 v[60:61], v29, s[44:47], s65 offen offset:0 sc1
    buffer_store_dwordx2 v[62:63], v29, s[44:47], s65 offen offset:64 sc1
    buffer_store_dwordx2 v[64:65], v29, s[44:47], s65 offen offset:128 sc1
    buffer_store_dwordx2 v[66:67], v29, s[44:47], s65 offen offset:192 sc1
    s_mov_b64 exec, -1
    v_mov_b32 v7, 0
    v_mov_b32 v6, 1
    s_mov_b64 s[62:63], exec
    s_mov_b64 exec, 1
    ds_add_u32 v7, v6 offset:20
    s_mov_b64 exec, s[62:63]
    s_branch L_mod_fin
L_mod_noA:
    s_barrier
    v_mov_b32 v7, 0
    v_mov_b32 v6, 1
    s_mov_b64 s[62:63], exec
    s_mov_b64 exec, 1
    ds_add_u32 v7, v6 offset:20
    s_mov_b64 exec, s[62:63]
    s_waitcnt lgkmcnt(0)
    s_add_u32 s6, s6, 0x7f4a7c15
    s_add_u32 s7, s7, 0x9e3779b9
L_mod_fin:
    v_mov_b32 v7, 0
    s_mov_b32 s61, 0x400000
Lw_1:
    ds_read_b32 v6, v7 offset:20
    s_waitcnt lgkmcnt(0)
    v_readfirstlane_b32 s60, v6
    s_nop 2
    s_cmp_ge_u32 s60, 1
    s_cbranch_scc1 Ld_2
    s_sub_u32 s61, s61, 1
    s_cbranch_scc1 L_abort
    s_branch Lw_1
Ld_2:
    s_cmp_lt_u32 s2, 12
    s_cbranch_scc1 L_mod_nob
    s_sub_u32 s53, s3, 1
    s_sub_u32 s65, s2, 36
    s_cmp_ge_u32 s2, 36
    s_cbranch_scc1 L_mod_bgo
    s_mov_b32 s65, s2
    s_branch L_mod_bgo
    s_mov_b32 s98, s65
    s_cmp_gt_u32 s3, 4
    s_cbranch_scc1 L_mod_q2
    s_lshl_b32 s38, s4, 10
    s_lshl_b32 s39, s3, 8
    s_add_u32 s38, s38, s39
    s_add_u32 s38, s38, 32512
    s_add_u32 s36, s34, s38
    s_addc_u32 s37, s35, 0
    s_mov_b32 s42, 0x40000
    s_branch Lqf_5
Lqf_3:
    s_sleep 4
Lqf_5:
    s_load_dwordx2 s[40:41], s[36:37], 128 glc
    s_load_dwordx16 s[48:63], s[36:37], 0 glc
    s_load_dwordx16 s[64:79], s[36:37], 64 glc
    s_sub_u32 s42, s42, 1
    s_cbranch_scc1 L_abort
    s_waitcnt lgkmcnt(0)
    s_cmp_lg_u32 s41, s7
    s_cbranch_scc1 Lqf_3
    s_add_u32 s43, s48, s7
    s_add_u32 s43, s43, s49
    s_add_u32 s43, s43, s50
    s_add_u32 s43, s43, s51
    s_add_u32 s43, s43, s52
    s_add_u32 s43, s43, s53
    s_add_u32 s43, s43, s54
    s_add_u32 s43, s43, s55
    s_add_u32 s43, s43, s56
    s_add_u32 s43, s43, s57
    s_add_u32 s43, s43, s58
    s_add_u32 s43, s43, s59
    s_add_u32 s43, s43, s60
    s_add_u32 s43, s43, s61
    s_add_u32 s43, s43, s62
    s_add_u32 s43, s43, s63
    s_add_u32 s43, s43, s64
    s_add_u32 s43, s43, s65
    s_add_u32 s43, s43, s66
    s_add_u32 s43, s43, s67
    s_add_u32 s43, s43, s68
    s_add_u32 s43, s43, s69
    s_add_u32 s43, s43, s70
    s_add_u32 s43, s43, s71
    s_add_u32 s43, s43, s72
    s_add_u32 s43, s43, s73
    s_add_u32 s43, s43, s74
    s_add_u32 s43, s43, s75
    s_add_u32 s43, s43, s76
    s_add_u32 s43, s43, s77
    s_add_u32 s43, s43, s78
    s_add_u32 s43, s43, s79
    s_cmp_lg_u32 s43, s40
    s_cbranch_scc1 Lqf_5
    v_writelane_b32 v20, s48, 0
    v_writelane_b32 v20, s49, 1
    v_writelane_b32 v20, s50, 2
    v_writelane_b32 v20, s51, 3
    v_writelane_b32 v20, s52, 4
    v_writelane_b32 v20, s53, 5
    v_writelane_b32 v20, s54, 6
    v_writelane_b32 v20, s55, 7
    v_writelane_b32 v20, s56, 8
    v_writelane_b32 v20, s57, 9
    v_writelane_b32 v20, s58, 10
    v_writelane_b32 v20, s59, 11
    v_writelane_b32 v20, s60, 12
    v_writelane_b32 v20, s61, 13
    v_writelane_b32 v20, s62, 14
    v_writelane_b32 v20, s63, 15
    v_writelane_b32 v20, s64, 16
    v_writelane_b32 v20, s65, 17
    v_writelane_b32 v20, s66, 18
    v_writelane_b32 v20, s67, 19
    v_writelane_b32 v20, s68, 20
    v_writelane_b32 v20, s69, 21
    v_writelane_b32 v20, s70, 22
    v_writelane_b32 v20, s71, 23
    v_writelane_b32 v20, s72, 24
    v_writelane_b32 v20, s73, 25
    v_writelane_b32 v20, s74, 26
    v_writelane_b32 v20, s75, 27
    v_writelane_b32 v20, s76, 28
    v_writelane_b32 v20, s77, 29
    v_writelane_b32 v20, s78, 30
    v_writelane_b32 v20, s79, 31
    v_and_b32 v21, 3, v1
    v_lshlrev_b32 v21, 2, v21
    v_bfe_u32 v22, v1, 2, 2
    v_add_u32 v21, v21, v22
    v_and_b32 v22, 16, v1
    v_add_u32 v21, v21, v22
    v_lshlrev_b32 v21, 2, v21
    s_lshl_b32 s38, s3, 7
    v_add_u32 v21, s38, v21
    s_mov_b64 exec, 0xffffffff
    ds_write_b32 v21, v20 offset:384
    s_mov_b64 exec, -1
    s_mov_b32 s44, s34
    s_mov_b32 s45, s35
    s_mov_b32 s46, 1073741824
    s_mov_b32 s47, 0x20000
    v_mov_b32 v7, 0
    v_mov_b32 v6, 1
    s_mov_b64 s[62:63], exec
    s_mov_b64 exec, 1
    ds_add_u32 v7, v6 offset:0
    s_mov_b64 exec, s[62:63]
L_mod_q2:
    s_mov_b32 s65, s98
    s_sub_u32 s53, s3, 1
    s_mov_b32 s100, 1
    v_mov_b32 v7, 0
    s_mov_b32 s61, 0x400000
Lw_6:
    ds_read_b32 v6, v7 offset:48
    s_waitcnt lgkmcnt(0)
    v_readfirstlane_b32 s60, v6
    s_nop 2
    s_cmp_ge_u32 s60, 3
    s_cbranch_scc1 Ld_7
    s_sub_u32 s61, s61, 1
    s_cbranch_scc1 L_abort
    s_sleep 2
    s_branch Lw_6
Ld_7:
    s_branch L_mod_bgo2
L_mod_bgo:
    s_mov_b32 s100, 0
L_mod_bgo2:
    s_mov_b32 s36, s28
    s_mov_b32 s37, s29
    s_mov_b32 s38, 3981312
    s_mov_b32 s39, 0x20000
    s_mov_b32 s40, s26
    s_mov_b32 s41, s27
    s_mov_b32 s42, 1152
    s_mov_b32 s43, 0x20000
    v_lshlrev_b32 v4, 1, v1
    s_mul_i32 s66, s53, 96
    s_lshl_b32 s59, s66, 1
    buffer_load_ushort v17, v4, s[40:43], s59 offen
    buffer_load_ushort v18, v4, s[40:43], s59 offen offset:128
    v_lshrrev_b32 v13, 3, v2
    v_lshl_add_u32 v13, v13, 2, v3
    v_mul_u32_u24 v5, 6912, v13
    v_and_b32 v7, 7, v2
    v_lshl_add_u32 v5, v7, 4, v5
    v_lshlrev_b32 v31, 2, v13
    s_lshl_b32 s67, s53, 9
    v_add_u32 v31, s67, v31
    v_lshlrev_b32 v30, 2, v1
    v_add_u32 v30, s67, v30
    s_mul_i32 s58, s66, 6912
    s_lshl_b32 s59, s65, 7
    s_add_u32 s58, s58, s59
    s_add_u32 s58, s58, 2304
    buffer_load_dwordx4 v[56:59], v5, s[36:39], s58 offen nt
    s_add_u32 s58, s58, 55296
    buffer_load_dwordx4 v[60:63], v5, s[36:39], s58 offen nt
    s_add_u32 s58, s58, 55296
    buffer_load_dwordx4 v[64:67], v5, s[36:39], s58 offen nt
    s_add_u32 s58, s58, 55296
    buffer_load_dwordx4 v[68:71], v5, s[36:39], s58 offen nt
    s_add_u32 s58, s58, 55296
    buffer_load_dwordx4 v[72:75], v5, s[36:39], s58 offen nt
    s_add_u32 s58, s58, 55296
    buffer_load_dwordx4 v[76:79], v5, s[36:39], s58 offen nt
    s_add_u32 s58, s58, 55296
    buffer_load_dwordx4 v[80:83], v5, s[36:39], s58 offen nt
    s_add_u32 s58, s58, 55296
    buffer_load_dwordx4 v[84:87], v5, s[36:39], s58 offen nt
    s_add_u32 s58, s58, 55296
    buffer_load_dwordx4 v[88:91], v5, s[36:39], s58 offen nt
    s_add_u32 s58, s58, 55296
    buffer_load_dwordx4 v[92:95], v5, s[36:39], s58 offen nt
    s_add_u32 s58, s58, 55296
    buffer_load_dwordx4 v[96:99], v5, s[36:39], s58 offen nt
    s_add_u32 s58, s58, 55296
    buffer_load_dwordx4 v[100:103], v5, s[36:39], s58 offen nt
    v_mov_b32 v7, 0
    v_mov_b32 v6, 1
    s_mov_b64 s[62:63], exec
    s_mov_b64 exec, 1
    ds_add_u32 v7, v6 offset:44
    s_mov_b64 exec, s[62:63]
    v_and_b32 v6, 1, v2
    v_lshlrev_b32 v6, 4, v6
    v_mov_b32 v7, 0xffff
    v_lshlrev_b32 v7, v6, v7
    v_bfe_u32 v6, v2, 1, 2
    v_cmp_eq_u32 vcc, 0, v6
    s_nop 1
    v_cndmask_b32 v8, 0, v7, vcc
    v_cmp_eq_u32 vcc, 1, v6
    s_nop 1
    v_cndmask_b32 v9, 0, v7, vcc
    v_cmp_eq_u32 vcc, 2, v6
    s_nop 1
    v_cndmask_b32 v10, 0, v7, vcc
    v_cmp_eq_u32 vcc, 3, v6
    s_nop 1
    v_cndmask_b32 v11, 0, v7, vcc
    s_waitcnt vmcnt(12)
    v_mov_b32 v34, s6
    v_mov_b32 v35, s7
    v_mov_b32 v38, s6
    v_mov_b32 v39, s7
    s_mov_b32 s60, 0xbfb8aa3b
    v_lshlrev_b32 v17, 16, v17
    v_lshlrev_b32 v18, 16, v18
    v_mul_f32 v19, s60, v17
    v_mul_f32 v20, s60, v18
    v_exp_f32 v19, v19
    v_exp_f32 v20, v20
    v_add_f32 v19, 1.0, v19
    v_add_f32 v20, 1.0, v20
    v_rcp_f32 v19, v19
    v_rcp_f32 v20, v20
    v_mul_f32 v17, v17, v19
    v_mul_f32 v18, v18, v20
    v_cvt_pk_bf16_f32 v17, v17, v17
    v_cvt_pk_bf16_f32 v18, v18, v18
    ds_write_b32 v30, v17 offset:1280
    ds_write_b32 v30, v18 offset:1536
    ds_read_b32 v104, v31 offset:1280
    ds_read_b32 v105, v31 offset:1312
    ds_read_b32 v106, v31 offset:1344
    ds_read_b32 v107, v31 offset:1376
    ds_read_b32 v108, v31 offset:1408
    ds_read_b32 v109, v31 offset:1440
    ds_read_b32 v110, v31 offset:1472
    ds_read_b32 v111, v31 offset:1504
    ds_read_b32 v112, v31 offset:1536
    ds_read_b32 v113, v31 offset:1568
    ds_read_b32 v114, v31 offset:1600
    ds_read_b32 v115, v31 offset:1632
    s_waitcnt vmcnt(0) lgkmcnt(0)
    v_and_b32 v120, v104, v8
    v_and_b32 v121, v104, v9
    v_and_b32 v122, v104, v10
    v_and_b32 v123, v104, v11
    v_and_b32 v124, v105, v8
    v_and_b32 v125, v105, v9
    v_and_b32 v126, v105, v10
    v_and_b32 v127, v105, v11
    v_mfma_f32_16x16x32_bf16 v[116:119], v[56:59], v[120:123], 0
    v_and_b32 v120, v106, v8
    v_and_b32 v121, v106, v9
    v_and_b32 v122, v106, v10
    v_and_b32 v123, v106, v11
    v_mfma_f32_16x16x32_bf16 v[116:119], v[60:63], v[124:127], v[116:119]
    v_and_b32 v124, v107, v8
    v_and_b32 v125, v107, v9
    v_and_b32 v126, v107, v10
    v_and_b32 v127, v107, v11
    v_mfma_f32_16x16x32_bf16 v[116:119], v[64:67], v[120:123], v[116:119]
    v_and_b32 v120, v108, v8
    v_and_b32 v121, v108, v9
    v_and_b32 v122, v108, v10
    v_and_b32 v123, v108, v11
    v_mfma_f32_16x16x32_bf16 v[116:119], v[68:71], v[124:127], v[116:119]
    v_and_b32 v124, v109, v8
    v_and_b32 v125, v109, v9
    v_and_b32 v126, v109, v10
    v_and_b32 v127, v109, v11
    v_mfma_f32_16x16x32_bf16 v[116:119], v[72:75], v[120:123], v[116:119]
    v_and_b32 v120, v110, v8
    v_and_b32 v121, v110, v9
    v_and_b32 v122, v110, v10
    v_and_b32 v123, v110, v11
    v_mfma_f32_16x16x32_bf16 v[116:119], v[76:79], v[124:127], v[116:119]
    v_and_b32 v124, v111, v8
    v_and_b32 v125, v111, v9
    v_and_b32 v126, v111, v10
    v_and_b32 v127, v111, v11
    v_mfma_f32_16x16x32_bf16 v[116:119], v[80:83], v[120:123], v[116:119]
    v_and_b32 v120, v112, v8
    v_and_b32 v121, v112, v9
    v_and_b32 v122, v112, v10
    v_and_b32 v123, v112, v11
    v_mfma_f32_16x16x32_bf16 v[116:119], v[84:87], v[124:127], v[116:119]
    v_and_b32 v124, v113, v8
    v_and_b32 v125, v113, v9
    v_and_b32 v126, v113, v10
    v_and_b32 v127, v113, v11
    v_mfma_f32_16x16x32_bf16 v[116:119], v[88:91], v[120:123], v[116:119]
    v_and_b32 v120, v114, v8
    v_and_b32 v121, v114, v9
    v_and_b32 v122, v114, v10
    v_and_b32 v123, v114, v11
    v_mfma_f32_16x16x32_bf16 v[116:119], v[92:95], v[124:127], v[116:119]
    v_and_b32 v124, v115, v8
    v_and_b32 v125, v115, v9
    v_and_b32 v126, v115, v10
    v_and_b32 v127, v115, v11
    v_mfma_f32_16x16x32_bf16 v[116:119], v[96:99], v[120:123], v[116:119]
    s_nop 0
    v_mfma_f32_16x16x32_bf16 v[116:119], v[100:103], v[124:127], v[116:119]
    s_lshl_b32 s59, s53, 10
    v_lshlrev_b32 v16, 4, v1
    v_add_u32 v19, s59, v16
    s_nop 4
    ds_write_b128 v19, v[116:119] offset:10752
    v_mov_b32 v7, 0
    v_mov_b32 v6, 1
    s_mov_b64 s[62:63], exec
    s_mov_b64 exec, 1
    ds_add_rtn_u32 v6, v7, v6 offset:36
    s_waitcnt lgkmcnt(0)
    v_readfirstlane_b32 s60, v6
    s_mov_b64 exec, s[62:63]
    s_nop 1
    s_cmp_lg_u32 s60, 5
    s_cbranch_scc1 L_modb_done
    ds_read_b128 v[56:59], v16 offset:10752
    ds_read_b128 v[60:63], v16 offset:11776
    ds_read_b128 v[64:67], v16 offset:12800
    ds_read_b128 v[68:71], v16 offset:13824
    ds_read_b128 v[72:75], v16 offset:14848
    ds_read_b128 v[76:79], v16 offset:15872
    s_waitcnt lgkmcnt(0)
    v_add_f32 v56, v56, v60
    v_add_f32 v57, v57, v61
    v_add_f32 v58, v58, v62
    v_add_f32 v59, v59, v63
    v_add_f32 v64, v64, v68
    v_add_f32 v65, v65, v69
    v_add_f32 v66, v66, v70
    v_add_f32 v67, v67, v71
    v_add_f32 v72, v72, v76
    v_add_f32 v73, v73, v77
    v_add_f32 v74, v74, v78
    v_add_f32 v75, v75, v79
    v_add_f32 v56, v56, v64
    v_add_f32 v57, v57, v65
    v_add_f32 v58, v58, v66
    v_add_f32 v59, v59, v67
    v_add_f32 v56, v56, v72
    v_add_f32 v57, v57, v73
    v_add_f32 v58, v58, v74
    v_add_f32 v59, v59, v75
    v_mov_b32 v60, v56
    v_mov_b32 v61, v57
    v_mov_b32 v62, v58
    v_mov_b32 v63, v59
    v_permlane32_swap_b32 v56, v60
    v_permlane32_swap_b32 v57, v61
    v_permlane32_swap_b32 v58, v62
    v_permlane32_swap_b32 v59, v63
    v_add_f32_dpp v56, v60, v56 row_shl:8 row_mask:0xf bank_mask:0xf
    v_add_f32_dpp v57, v61, v57 row_shl:8 row_mask:0xf bank_mask:0xf
    v_add_f32_dpp v58, v62, v58 row_shl:8 row_mask:0xf bank_mask:0xf
    v_add_f32_dpp v59, v63, v59 row_shl:8 row_mask:0xf bank_mask:0xf
    v_cvt_pk_bf16_f32 v56, v56, v56
    v_cvt_pk_bf16_f32 v57, v57, v57
    v_cvt_pk_bf16_f32 v58, v58, v58
    v_cvt_pk_bf16_f32 v59, v59, v59
    v_lshlrev_b32 v56, 16, v56
    v_lshlrev_b32 v57, 16, v57
    v_lshlrev_b32 v58, 16, v58
    v_lshlrev_b32 v59, 16, v59
    v_mov_b32 v32, v56
    v_mov_b32 v33, v57
    v_mov_b32 v36, v58
    v_mov_b32 v37, v59
    s_lshl_b32 s59, s65, 9
    s_add_u32 s59, s59, 131072
    v_lshlrev_b32 v19, 3, v3
    v_add_u32 v19, v19, v2
    v_lshlrev_b32 v19, 5, v19
    s_mov_b64 exec, 0x00ff00ff
    buffer_store_dwordx4 v[32:35], v19, s[44:47], s59 offen sc1
    buffer_store_dwordx4 v[36:39], v19, s[44:47], s59 offen offset:16 sc1
    s_mov_b64 exec, -1
L_modb_done:
    s_cmp_lg_u32 s100, 0
    s_cbranch_scc1 L_exit
    s_branch L_mod_q
L_mod_nob:
    v_mov_b32 v7, 0
    v_mov_b32 v6, 1
    s_mov_b64 s[62:63], exec
    s_mov_b64 exec, 1
    ds_add_u32 v7, v6 offset:44
    s_mov_b64 exec, s[62:63]
L_mod_q:
    s_cmp_gt_u32 s3, 4
    s_cbranch_scc1 L_exit
    s_lshl_b32 s38, s4, 10
    s_lshl_b32 s39, s3, 8
    s_add_u32 s38, s38, s39
    s_add_u32 s38, s38, 32512
    s_add_u32 s36, s34, s38
    s_addc_u32 s37, s35, 0
    s_mov_b32 s42, 0x40000
    s_branch Lqf_10
Lqf_8:
    s_sleep 4
Lqf_10:
    s_load_dwordx2 s[40:41], s[36:37], 128 glc
    s_load_dwordx16 s[48:63], s[36:37], 0 glc
    s_load_dwordx16 s[64:79], s[36:37], 64 glc
    s_sub_u32 s42, s42, 1
    s_cbranch_scc1 L_abort
    s_waitcnt lgkmcnt(0)
    s_cmp_lg_u32 s41, s7
    s_cbranch_scc1 Lqf_8
    s_add_u32 s43, s48, s7
    s_add_u32 s43, s43, s49
    s_add_u32 s43, s43, s50
    s_add_u32 s43, s43, s51
    s_add_u32 s43, s43, s52
    s_add_u32 s43, s43, s53
    s_add_u32 s43, s43, s54
    s_add_u32 s43, s43, s55
    s_add_u32 s43, s43, s56
    s_add_u32 s43, s43, s57
    s_add_u32 s43, s43, s58
    s_add_u32 s43, s43, s59
    s_add_u32 s43, s43, s60
    s_add_u32 s43, s43, s61
    s_add_u32 s43, s43, s62
    s_add_u32 s43, s43, s63
    s_add_u32 s43, s43, s64
    s_add_u32 s43, s43, s65
    s_add_u32 s43, s43, s66
    s_add_u32 s43, s43, s67
    s_add_u32 s43, s43, s68
    s_add_u32 s43, s43, s69
    s_add_u32 s43, s43, s70
    s_add_u32 s43, s43, s71
    s_add_u32 s43, s43, s72
    s_add_u32 s43, s43, s73
    s_add_u32 s43, s43, s74
    s_add_u32 s43, s43, s75
    s_add_u32 s43, s43, s76
    s_add_u32 s43, s43, s77
    s_add_u32 s43, s43, s78
    s_add_u32 s43, s43, s79
    s_cmp_lg_u32 s43, s40
    s_cbranch_scc1 Lqf_10
    v_writelane_b32 v20, s48, 0
    v_writelane_b32 v20, s49, 1
    v_writelane_b32 v20, s50, 2
    v_writelane_b32 v20, s51, 3
    v_writelane_b32 v20, s52, 4
    v_writelane_b32 v20, s53, 5
    v_writelane_b32 v20, s54, 6
    v_writelane_b32 v20, s55, 7
    v_writelane_b32 v20, s56, 8
    v_writelane_b32 v20, s57, 9
    v_writelane_b32 v20, s58, 10
    v_writelane_b32 v20, s59, 11
    v_writelane_b32 v20, s60, 12
    v_writelane_b32 v20, s61, 13
    v_writelane_b32 v20, s62, 14
    v_writelane_b32 v20, s63, 15
    v_writelane_b32 v20, s64, 16
    v_writelane_b32 v20, s65, 17
    v_writelane_b32 v20, s66, 18
    v_writelane_b32 v20, s67, 19
    v_writelane_b32 v20, s68, 20
    v_writelane_b32 v20, s69, 21
    v_writelane_b32 v20, s70, 22
    v_writelane_b32 v20, s71, 23
    v_writelane_b32 v20, s72, 24
    v_writelane_b32 v20, s73, 25
    v_writelane_b32 v20, s74, 26
    v_writelane_b32 v20, s75, 27
    v_writelane_b32 v20, s76, 28
    v_writelane_b32 v20, s77, 29
    v_writelane_b32 v20, s78, 30
    v_writelane_b32 v20, s79, 31
    v_and_b32 v21, 3, v1
    v_lshlrev_b32 v21, 2, v21
    v_bfe_u32 v22, v1, 2, 2
    v_add_u32 v21, v21, v22
    v_and_b32 v22, 16, v1
    v_add_u32 v21, v21, v22
    v_lshlrev_b32 v21, 2, v21
    s_lshl_b32 s38, s3, 7
    v_add_u32 v21, s38, v21
    s_mov_b64 exec, 0xffffffff
    ds_write_b32 v21, v20 offset:384
    s_mov_b64 exec, -1
    s_mov_b32 s44, s34
    s_mov_b32 s45, s35
    s_mov_b32 s46, 1073741824
    s_mov_b32 s47, 0x20000
    v_mov_b32 v7, 0
    v_mov_b32 v6, 1
    s_mov_b64 s[62:63], exec
    s_mov_b64 exec, 1
    ds_add_u32 v7, v6 offset:0
    s_mov_b64 exec, s[62:63]
    s_branch L_exit
L_wq:
    s_mov_b32 s36, s14
    s_mov_b32 s37, s15
    s_mov_b32 s38, 4718592
    s_mov_b32 s39, 0x20000
    s_mov_b32 s40, s8
    s_mov_b32 s41, s9
    s_mov_b32 s42, 1152
    s_mov_b32 s43, 0x20000
    s_sub_u32 s53, s3, 1
    s_sub_u32 s54, s5, 3
    s_mul_i32 s57, s53, 96
    v_lshlrev_b32 v4, 1, v1
    buffer_load_ushort v32, v4, s[40:43], 0 offen offset:0
    buffer_load_ushort v33, v4, s[40:43], 0 offen offset:128
    buffer_load_ushort v34, v4, s[40:43], 0 offen offset:256
    buffer_load_ushort v35, v4, s[40:43], 0 offen offset:384
    buffer_load_ushort v36, v4, s[40:43], 0 offen offset:512
    buffer_load_ushort v37, v4, s[40:43], 0 offen offset:640
    buffer_load_ushort v38, v4, s[40:43], 0 offen offset:768
    buffer_load_ushort v39, v4, s[40:43], 0 offen offset:896
    buffer_load_ushort v40, v4, s[40:43], 0 offen offset:1024
    v_and_b32 v6, 31, v1
    v_lshlrev_b32 v7, 1, v6
    s_lshl_b32 s58, s57, 1
    buffer_load_ushort v41, v4, s[40:43], s58 offen
    buffer_load_ushort v42, v7, s[40:43], s58 offen offset:128
    v_lshrrev_b32 v13, 3, v2
    v_lshl_add_u32 v13, v13, 2, v3
    v_lshlrev_b32 v5, 13, v13
    v_and_b32 v7, 7, v2
    v_lshl_add_u32 v5, v7, 4, v5
    s_lshl_b32 s58, s57, 13
    s_lshl_b32 s59, s4, 9
    s_add_u32 s58, s58, s59
    s_lshl_b32 s59, s54, 7
    s_add_u32 s58, s58, s59
    buffer_load_dwordx4 v[56:59], v5, s[36:39], s58 offen nt
    s_add_u32 s58, s58, 65536
    buffer_load_dwordx4 v[60:63], v5, s[36:39], s58 offen nt
    s_add_u32 s58, s58, 65536
    buffer_load_dwordx4 v[64:67], v5, s[36:39], s58 offen nt
    s_add_u32 s58, s58, 65536
    buffer_load_dwordx4 v[68:71], v5, s[36:39], s58 offen nt
    s_add_u32 s58, s58, 65536
    buffer_load_dwordx4 v[72:75], v5, s[36:39], s58 offen nt
    s_add_u32 s58, s58, 65536
    buffer_load_dwordx4 v[76:79], v5, s[36:39], s58 offen nt
    s_add_u32 s58, s58, 65536
    buffer_load_dwordx4 v[80:83], v5, s[36:39], s58 offen nt
    s_add_u32 s58, s58, 65536
    buffer_load_dwordx4 v[84:87], v5, s[36:39], s58 offen nt
    s_add_u32 s58, s58, 65536
    buffer_load_dwordx4 v[88:91], v5, s[36:39], s58 offen nt
    s_add_u32 s58, s58, 65536
    buffer_load_dwordx4 v[92:95], v5, s[36:39], s58 offen nt
    s_add_u32 s58, s58, 65536
    buffer_load_dwordx4 v[96:99], v5, s[36:39], s58 offen nt
    s_add_u32 s58, s58, 65536
    buffer_load_dwordx4 v[100:103], v5, s[36:39], s58 offen nt
    s_barrier
    v_add_u32 v28, s57, v1
    v_lshlrev_b32 v28, 3, v28
    v_add_u32 v29, s57, v6
    v_lshlrev_b32 v29, 3, v29
    v_add_u32 v29, 512, v29
    v_lshlrev_b32 v31, 2, v13
    s_lshl_b32 s67, s53, 10
    v_add_u32 v31, s67, v31
    v_lshlrev_b32 v30, 2, v1
    v_add_u32 v30, s67, v30
    v_lshlrev_b32 v27, 2, v6
    v_add_u32 v27, s67, v27
    v_and_b32 v6, 1, v2
    v_lshlrev_b32 v6, 4, v6
    v_mov_b32 v7, 0xffff
    v_lshlrev_b32 v7, v6, v7
    v_bfe_u32 v6, v2, 1, 2
    v_cmp_eq_u32 vcc, 0, v6
    s_nop 1
    v_cndmask_b32 v8, 0, v7, vcc
    v_cmp_eq_u32 vcc, 1, v6
    s_nop 1
    v_cndmask_b32 v9, 0, v7, vcc
    v_cmp_eq_u32 vcc, 2, v6
    s_nop 1
    v_cndmask_b32 v10, 0, v7, vcc
    v_cmp_eq_u32 vcc, 3, v6
    s_nop 1
    v_cndmask_b32 v11, 0, v7, vcc
    s_waitcnt vmcnt(12)
    s_waitcnt lgkmcnt(0)
    s_add_u32 s6, s6, 0x7f4a7c15
    s_add_u32 s7, s7, 0x9e3779b9
    v_lshlrev_b32 v32, 16, v32
    v_lshlrev_b32 v33, 16, v33
    v_lshlrev_b32 v34, 16, v34
    v_lshlrev_b32 v35, 16, v35
    v_lshlrev_b32 v36, 16, v36
    v_lshlrev_b32 v37, 16, v37
    v_lshlrev_b32 v38, 16, v38
    v_lshlrev_b32 v39, 16, v39
    v_lshlrev_b32 v40, 16, v40
    v_lshlrev_b32 v41, 16, v41
    v_lshlrev_b32 v42, 16, v42
    v_add_f32 v18, v32, v33
    v_add_f32 v18, v18, v34
    v_add_f32 v18, v18, v35
    v_add_f32 v18, v18, v36
    v_add_f32 v18, v18, v37
    v_add_f32 v18, v18, v38
    v_add_f32 v18, v18, v39
    v_add_f32 v18, v18, v40
    s_nop 1
    v_add_f32_dpp v18, v18, v18 quad_perm:[1,0,3,2] row_mask:0xf bank_mask:0xf
    s_nop 1
    v_add_f32_dpp v18, v18, v18 quad_perm:[2,3,0,1] row_mask:0xf bank_mask:0xf
    s_nop 1
    v_add_f32_dpp v18, v18, v18 row_half_mirror row_mask:0xf bank_mask:0xf
    s_nop 1
    v_add_f32_dpp v18, v18, v18 row_mirror row_mask:0xf bank_mask:0xf
    v_mov_b32 v19, v18
    s_nop 1
    v_permlane16_swap_b32 v18, v19
    v_add_f32 v18, v18, v19
    v_mov_b32 v19, v18
    s_nop 1
    v_permlane32_swap_b32 v18, v19
    v_add_f32 v18, v18, v19
    s_mov_b32 s60, 0x3ae38e39
    v_mul_f32 v18, s60, v18
    v_sub_f32 v19, v32, v18
    v_mul_f32 v17, v19, v19
    v_sub_f32 v19, v33, v18
    v_fmac_f32 v17, v19, v19
    v_sub_f32 v19, v34, v18
    v_fmac_f32 v17, v19, v19
    v_sub_f32 v19, v35, v18
    v_fmac_f32 v17, v19, v19
    v_sub_f32 v19, v36, v18
    v_fmac_f32 v17, v19, v19
    v_sub_f32 v19, v37, v18
    v_fmac_f32 v17, v19, v19
    v_sub_f32 v19, v38, v18
    v_fmac_f32 v17, v19, v19
    v_sub_f32 v19, v39, v18
    v_fmac_f32 v17, v19, v19
    v_sub_f32 v19, v40, v18
    v_fmac_f32 v17, v19, v19
    s_nop 1
    v_add_f32_dpp v17, v17, v17 quad_perm:[1,0,3,2] row_mask:0xf bank_mask:0xf
    s_nop 1
    v_add_f32_dpp v17, v17, v17 quad_perm:[2,3,0,1] row_mask:0xf bank_mask:0xf
    s_nop 1
    v_add_f32_dpp v17, v17, v17 row_half_mirror row_mask:0xf bank_mask:0xf
    s_nop 1
    v_add_f32_dpp v17, v17, v17 row_mirror row_mask:0xf bank_mask:0xf
    v_mov_b32 v19, v17
    s_nop 1
    v_permlane16_swap_b32 v17, v19
    v_add_f32 v17, v17, v19
    v_mov_b32 v19, v17
    s_nop 1
    v_permlane32_swap_b32 v17, v19
    v_add_f32 v17, v17, v19
    v_mul_f32 v17, s60, v17
    v_cvt_pk_bf16_f32 v17, v17, v17
    v_lshlrev_b32 v17, 16, v17
    v_add_f32 v17, 0x3727c5ac, v17
    v_cvt_pk_bf16_f32 v17, v17, v17
    v_lshlrev_b32 v17, 16, v17
    v_sqrt_f32 v17, v17
    s_nop 0
    v_cvt_pk_bf16_f32 v17, v17, v17
    v_lshlrev_b32 v17, 16, v17
    v_rcp_f32 v17, v17
    v_cvt_pk_bf16_f32 v16, v18, v18
    v_lshlrev_b32 v16, 16, v16
    v_sub_f32 v41, v41, v16
    v_sub_f32 v42, v42, v16
    v_cvt_pk_bf16_f32 v41, v41, v41
    v_cvt_pk_bf16_f32 v42, v42, v42
    v_lshlrev_b32 v41, 16, v41
    v_lshlrev_b32 v42, 16, v42
    v_mul_f32 v41, v41, v17
    v_mul_f32 v42, v42, v17
    v_cvt_pk_bf16_f32 v41, v41, v41
    v_cvt_pk_bf16_f32 v42, v42, v42
    v_lshlrev_b32 v41, 16, v41
    v_lshlrev_b32 v42, 16, v42
    v_mov_b32 v20, v41
    v_mov_b32 v21, v42
    s_mov_b32 s66, 4096
    s_mov_b32 s68, 13312
    s_mov_b32 s69, 8704
    s_mov_b32 s70, 17920
    s_waitcnt vmcnt(6)
    buffer_load_dwordx2 v[32:33], v28, s[44:47], s66 offen sc1
    buffer_load_dwordx2 v[34:35], v28, s[44:47], s68 offen sc1
    buffer_load_dwordx2 v[36:37], v28, s[44:47], s69 offen sc1
    buffer_load_dwordx2 v[38:39], v28, s[44:47], s70 offen sc1
    buffer_load_dwordx2 v[40:41], v29, s[44:47], s66 offen sc1
    buffer_load_dwordx2 v[42:43], v29, s[44:47], s68 offen sc1
    buffer_load_dwordx2 v[44:45], v29, s[44:47], s69 offen sc1
    buffer_load_dwordx2 v[46:47], v29, s[44:47], s70 offen sc1
    s_waitcnt vmcnt(11)
    buffer_load_dwordx2 v[104:105], v28, s[44:47], s66 offen sc1
    buffer_load_dwordx2 v[106:107], v28, s[44:47], s68 offen sc1
    buffer_load_dwordx2 v[108:109], v28, s[44:47], s69 offen sc1
    buffer_load_dwordx2 v[110:111], v28, s[44:47], s70 offen sc1
    buffer_load_dwordx2 v[112:113], v29, s[44:47], s66 offen sc1
    buffer_load_dwordx2 v[114:115], v29, s[44:47], s68 offen sc1
    buffer_load_dwordx2 v[116:117], v29, s[44:47], s69 offen sc1
    buffer_load_dwordx2 v[118:119], v29, s[44:47], s70 offen sc1
    s_waitcnt vmcnt(8)
    v_xor_b32 v6, s7, v33
    v_xor_b32 v7, s7, v35
    v_or_b32 v6, v6, v7
    v_xor_b32 v7, s7, v37
    v_or_b32 v6, v6, v7
    v_xor_b32 v7, s7, v39
    v_or_b32 v6, v6, v7
    v_xor_b32 v7, s7, v41
    v_or_b32 v6, v6, v7
    v_xor_b32 v7, s7, v43
    v_or_b32 v6, v6, v7
    v_xor_b32 v7, s7, v45
    v_or_b32 v6, v6, v7
    v_xor_b32 v7, s7, v47
    v_or_b32 v6, v6, v7
    v_cmp_ne_u32 vcc, 0, v6
    s_nop 4
    s_cbranch_vccz Lmp_11
    s_waitcnt vmcnt(0)
    v_xor_b32 v6, s7, v105
    v_xor_b32 v7, s7, v107
    v_or_b32 v6, v6, v7
    v_xor_b32 v7, s7, v109
    v_or_b32 v6, v6, v7
    v_xor_b32 v7, s7, v111
    v_or_b32 v6, v6, v7
    v_xor_b32 v7, s7, v113
    v_or_b32 v6, v6, v7
    v_xor_b32 v7, s7, v115
    v_or_b32 v6, v6, v7
    v_xor_b32 v7, s7, v117
    v_or_b32 v6, v6, v7
    v_xor_b32 v7, s7, v119
    v_or_b32 v6, v6, v7
    v_cmp_ne_u32 vcc, 0, v6
    s_nop 4
    s_cbranch_vccnz Lmp_13
    v_mov_b32 v32, v104
    v_mov_b32 v34, v106
    v_mov_b32 v36, v108
    v_mov_b32 v38, v110
    v_mov_b32 v40, v112
    v_mov_b32 v42, v114
    v_mov_b32 v44, v116
    v_mov_b32 v46, v118
    s_branch Lmp_11
Lmp_13:
    s_mov_b32 s64, 0x8000
Lp_14:
    buffer_load_dwordx2 v[32:33], v28, s[44:47], s66 offen sc1
    buffer_load_dwordx2 v[34:35], v28, s[44:47], s68 offen sc1
    buffer_load_dwordx2 v[36:37], v28, s[44:47], s69 offen sc1
    buffer_load_dwordx2 v[38:39], v28, s[44:47], s70 offen sc1
    buffer_load_dwordx2 v[40:41], v29, s[44:47], s66 offen sc1
    buffer_load_dwordx2 v[42:43], v29, s[44:47], s68 offen sc1
    buffer_load_dwordx2 v[44:45], v29, s[44:47], s69 offen sc1
    buffer_load_dwordx2 v[46:47], v29, s[44:47], s70 offen sc1
    s_waitcnt vmcnt(0)
    v_xor_b32 v6, s7, v33
    v_xor_b32 v7, s7, v35
    v_or_b32 v6, v6, v7
    v_xor_b32 v7, s7, v37
    v_or_b32 v6, v6, v7
    v_xor_b32 v7, s7, v39
    v_or_b32 v6, v6, v7
    v_xor_b32 v7, s7, v41
    v_or_b32 v6, v6, v7
    v_xor_b32 v7, s7, v43
    v_or_b32 v6, v6, v7
    v_xor_b32 v7, s7, v45
    v_or_b32 v6, v6, v7
    v_xor_b32 v7, s7, v47
    v_or_b32 v6, v6, v7
    v_cmp_ne_u32 vcc, 0, v6
    s_sub_u32 s64, s64, 1
    s_cbranch_scc1 L_abort
    s_nop 2
    s_cbranch_vccnz Lp_14
Lmp_11:
    s_waitcnt vmcnt(0)
    v_add_f32 v32, v32, v34
    v_add_f32 v36, v36, v38
    v_add_f32 v40, v40, v42
    v_add_f32 v44, v44, v46
    v_cvt_pk_bf16_f32 v32, v32, v32
    v_cvt_pk_bf16_f32 v36, v36, v36
    v_cvt_pk_bf16_f32 v40, v40, v40
    v_cvt_pk_bf16_f32 v44, v44, v44
    v_lshlrev_b32 v32, 16, v32
    v_lshlrev_b32 v36, 16, v36
    v_lshlrev_b32 v40, 16, v40
    v_lshlrev_b32 v44, 16, v44
    v_add_f32 v36, 1.0, v36
    v_add_f32 v44, 1.0, v44
    v_cvt_pk_bf16_f32 v36, v36, v36
    v_cvt_pk_bf16_f32 v44, v44, v44
    v_lshlrev_b32 v36, 16, v36
    v_lshlrev_b32 v44, 16, v44
    v_mul_f32 v20, v20, v36
    v_mul_f32 v21, v21, v44
    v_cvt_pk_bf16_f32 v20, v20, v20
    v_cvt_pk_bf16_f32 v21, v21, v21
    v_lshlrev_b32 v20, 16, v20
    v_lshlrev_b32 v21, 16, v21
    v_add_f32 v20, v20, v32
    v_add_f32 v21, v21, v40
    v_cvt_pk_bf16_f32 v20, v20, v20
    v_cvt_pk_bf16_f32 v21, v21, v21
    ds_write_b32 v30, v20 offset:16896
    ds_write_b32 v27, v21 offset:17152
    ds_read_b32 v104, v31 offset:16896
    ds_read_b32 v105, v31 offset:16928
    ds_read_b32 v106, v31 offset:16960
    ds_read_b32 v107, v31 offset:16992
    ds_read_b32 v108, v31 offset:17024
    ds_read_b32 v109, v31 offset:17056
    ds_read_b32 v110, v31 offset:17088
    ds_read_b32 v111, v31 offset:17120
    ds_read_b32 v112, v31 offset:17152
    ds_read_b32 v113, v31 offset:17184
    ds_read_b32 v114, v31 offset:17216
    ds_read_b32 v115, v31 offset:17248
    s_waitcnt lgkmcnt(0)
    v_and_b32 v120, v104, v8
    v_and_b32 v121, v104, v9
    v_and_b32 v122, v104, v10
    v_and_b32 v123, v104, v11
    v_and_b32 v124, v105, v8
    v_and_b32 v125, v105, v9
    v_and_b32 v126, v105, v10
    v_and_b32 v127, v105, v11
    v_mfma_f32_16x16x32_bf16 v[116:119], v[56:59], v[120:123], 0
    v_and_b32 v120, v106, v8
    v_and_b32 v121, v106, v9
    v_and_b32 v122, v106, v10
    v_and_b32 v123, v106, v11
    v_mfma_f32_16x16x32_bf16 v[116:119], v[60:63], v[124:127], v[116:119]
    v_and_b32 v124, v107, v8
    v_and_b32 v125, v107, v9
    v_and_b32 v126, v107, v10
    v_and_b32 v127, v107, v11
    v_mfma_f32_16x16x32_bf16 v[116:119], v[64:67], v[120:123], v[116:119]
    v_and_b32 v120, v108, v8
    v_and_b32 v121, v108, v9
    v_and_b32 v122, v108, v10
    v_and_b32 v123, v108, v11
    v_mfma_f32_16x16x32_bf16 v[116:119], v[68:71], v[124:127], v[116:119]
    v_and_b32 v124, v109, v8
    v_and_b32 v125, v109, v9
    v_and_b32 v126, v109, v10
    v_and_b32 v127, v109, v11
    v_mfma_f32_16x16x32_bf16 v[116:119], v[72:75], v[120:123], v[116:119]
    v_and_b32 v120, v110, v8
    v_and_b32 v121, v110, v9
    v_and_b32 v122, v110, v10
    v_and_b32 v123, v110, v11
    v_mfma_f32_16x16x32_bf16 v[116:119], v[76:79], v[124:127], v[116:119]
    v_and_b32 v124, v111, v8
    v_and_b32 v125, v111, v9
    v_and_b32 v126, v111, v10
    v_and_b32 v127, v111, v11
    v_mfma_f32_16x16x32_bf16 v[116:119], v[80:83], v[120:123], v[116:119]
    v_and_b32 v120, v112, v8
    v_and_b32 v121, v112, v9
    v_and_b32 v122, v112, v10
    v_and_b32 v123, v112, v11
    v_mfma_f32_16x16x32_bf16 v[116:119], v[84:87], v[124:127], v[116:119]
    v_and_b32 v124, v113, v8
    v_and_b32 v125, v113, v9
    v_and_b32 v126, v113, v10
    v_and_b32 v127, v113, v11
    v_mfma_f32_16x16x32_bf16 v[116:119], v[88:91], v[120:123], v[116:119]
    v_and_b32 v120, v114, v8
    v_and_b32 v121, v114, v9
    v_and_b32 v122, v114, v10
    v_and_b32 v123, v114, v11
    v_mfma_f32_16x16x32_bf16 v[116:119], v[92:95], v[124:127], v[116:119]
    v_and_b32 v124, v115, v8
    v_and_b32 v125, v115, v9
    v_and_b32 v126, v115, v10
    v_and_b32 v127, v115, v11
    v_mfma_f32_16x16x32_bf16 v[116:119], v[96:99], v[120:123], v[116:119]
    s_nop 0
    v_mfma_f32_16x16x32_bf16 v[116:119], v[100:103], v[124:127], v[116:119]
    s_lshl_b32 s59, s53, 10
    v_lshlrev_b32 v16, 4, v1
    v_add_u32 v19, s59, v16
    s_nop 4
    ds_write_b128 v19, v[116:119] offset:4608
    v_mov_b32 v7, 0
    v_mov_b32 v6, 1
    s_mov_b64 s[62:63], exec
    s_mov_b64 exec, 1
    ds_add_rtn_u32 v6, v7, v6 offset:16
    s_waitcnt lgkmcnt(0)
    v_readfirstlane_b32 s60, v6
    s_mov_b64 exec, s[62:63]
    s_nop 1
    s_cmp_lg_u32 s60, 5
    s_cbranch_scc1 L_wq_done
    ds_read_b128 v[56:59], v16 offset:4608
    ds_read_b128 v[60:63], v16 offset:5632
    ds_read_b128 v[64:67], v16 offset:6656
    ds_read_b128 v[68:71], v16 offset:7680
    ds_read_b128 v[72:75], v16 offset:8704
    ds_read_b128 v[76:79], v16 offset:9728
    s_waitcnt lgkmcnt(0)
    v_add_f32 v56, v56, v60
    v_add_f32 v57, v57, v61
    v_add_f32 v58, v58, v62
    v_add_f32 v59, v59, v63
    v_add_f32 v64, v64, v68
    v_add_f32 v65, v65, v69
    v_add_f32 v66, v66, v70
    v_add_f32 v67, v67, v71
    v_add_f32 v72, v72, v76
    v_add_f32 v73, v73, v77
    v_add_f32 v74, v74, v78
    v_add_f32 v75, v75, v79
    v_add_f32 v56, v56, v64
    v_add_f32 v57, v57, v65
    v_add_f32 v58, v58, v66
    v_add_f32 v59, v59, v67
    v_add_f32 v56, v56, v72
    v_add_f32 v57, v57, v73
    v_add_f32 v58, v58, v74
    v_add_f32 v59, v59, v75
    v_mov_b32 v60, v56
    v_mov_b32 v61, v57
    v_mov_b32 v62, v58
    v_mov_b32 v63, v59
    v_permlane32_swap_b32 v56, v60
    v_permlane32_swap_b32 v57, v61
    v_permlane32_swap_b32 v58, v62
    v_permlane32_swap_b32 v59, v63
    v_add_f32_dpp v56, v60, v56 row_shl:8 row_mask:0xf bank_mask:0xf
    v_add_f32_dpp v57, v61, v57 row_shl:8 row_mask:0xf bank_mask:0xf
    v_add_f32_dpp v58, v62, v58 row_shl:8 row_mask:0xf bank_mask:0xf
    v_add_f32_dpp v59, v63, v59 row_shl:8 row_mask:0xf bank_mask:0xf
    v_mov_b32_dpp v60, v56 quad_perm:[1,0,3,2] row_mask:0xf bank_mask:0xf
    v_mov_b32_dpp v61, v57 quad_perm:[1,0,3,2] row_mask:0xf bank_mask:0xf
    v_mov_b32_dpp v62, v58 quad_perm:[1,0,3,2] row_mask:0xf bank_mask:0xf
    v_mov_b32_dpp v63, v59 quad_perm:[1,0,3,2] row_mask:0xf bank_mask:0xf
    v_cvt_pk_bf16_f32 v56, v56, v60
    v_cvt_pk_bf16_f32 v57, v57, v61
    v_cvt_pk_bf16_f32 v58, v58, v62
    v_cvt_pk_bf16_f32 v59, v59, v63
    v_add_u32 v60, v56, v57
    v_add3_u32 v60, v60, v58, v59
    s_mov_b32 s60, 0x00550055
    s_mov_b32 s61, 0
    v_cndmask_b32 v60, 0, v60, s[60:61]
    s_nop 1
    v_add_u32_dpp v60, v60, v60 quad_perm:[2,3,0,1] row_mask:0xf bank_mask:0xf
    s_nop 1
    v_add_u32_dpp v60, v60, v60 row_shl:4 row_mask:0xf bank_mask:0xf bound_ctrl:0
    v_lshrrev_b32 v19, 1, v2
    v_lshl_add_u32 v19, v3, 2, v19
    v_lshlrev_b32 v19, 4, v19
    v_readlane_b32 s60, v60, 0
    v_readlane_b32 s61, v60, 16
    s_nop 2
    s_add_u32 s60, s60, s61
    s_add_u32 s60, s60, s7
    s_mov_b32 s61, 128
    v_writelane_b32 v56, s60, 1
    v_writelane_b32 v57, s7, 1
    v_writelane_b32 v19, s61, 1
    s_lshl_b32 s59, s4, 10
    s_lshl_b32 s60, s54, 8
    s_add_u32 s59, s59, s60
    s_add_u32 s59, s59, 32768
    s_mov_b64 exec, 0x00550057
    buffer_store_dwordx4 v[56:59], v19, s[44:47], s59 offen sc1
    s_mov_b64 exec, -1
    v_mov_b32 v7, 0
    v_mov_b32 v6, 1
    s_mov_b64 s[62:63], exec
    s_mov_b64 exec, 1
    ds_add_u32 v7, v6 offset:24
    s_mov_b64 exec, s[62:63]
L_wq_done:
    s_cmp_gt_u32 s3, 4
    s_cbranch_scc1 L_exit
    s_lshl_b32 s38, s4, 10
    s_lshl_b32 s39, s3, 8
    s_add_u32 s38, s38, s39
    s_add_u32 s38, s38, 32512
    s_add_u32 s36, s34, s38
    s_addc_u32 s37, s35, 0
    s_mov_b32 s42, 0x40000
    s_branch Lqf_18
Lqf_16:
    s_sleep 4
Lqf_18:
    s_load_dwordx2 s[40:41], s[36:37], 128 glc
    s_load_dwordx16 s[48:63], s[36:37], 0 glc
    s_load_dwordx16 s[64:79], s[36:37], 64 glc
    s_sub_u32 s42, s42, 1
    s_cbranch_scc1 L_abort
    s_waitcnt lgkmcnt(0)
    s_cmp_lg_u32 s41, s7
    s_cbranch_scc1 Lqf_16
    s_add_u32 s43, s48, s7
    s_add_u32 s43, s43, s49
    s_add_u32 s43, s43, s50
    s_add_u32 s43, s43, s51
    s_add_u32 s43, s43, s52
    s_add_u32 s43, s43, s53
    s_add_u32 s43, s43, s54
    s_add_u32 s43, s43, s55
    s_add_u32 s43, s43, s56
    s_add_u32 s43, s43, s57
    s_add_u32 s43, s43, s58
    s_add_u32 s43, s43, s59
    s_add_u32 s43, s43, s60
    s_add_u32 s43, s43, s61
    s_add_u32 s43, s43, s62
    s_add_u32 s43, s43, s63
    s_add_u32 s43, s43, s64
    s_add_u32 s43, s43, s65
    s_add_u32 s43, s43, s66
    s_add_u32 s43, s43, s67
    s_add_u32 s43, s43, s68
    s_add_u32 s43, s43, s69
    s_add_u32 s43, s43, s70
    s_add_u32 s43, s43, s71
    s_add_u32 s43, s43, s72
    s_add_u32 s43, s43, s73
    s_add_u32 s43, s43, s74
    s_add_u32 s43, s43, s75
    s_add_u32 s43, s43, s76
    s_add_u32 s43, s43, s77
    s_add_u32 s43, s43, s78
    s_add_u32 s43, s43, s79
    s_cmp_lg_u32 s43, s40
    s_cbranch_scc1 Lqf_18
    v_writelane_b32 v20, s48, 0
    v_writelane_b32 v20, s49, 1
    v_writelane_b32 v20, s50, 2
    v_writelane_b32 v20, s51, 3
    v_writelane_b32 v20, s52, 4
    v_writelane_b32 v20, s53, 5
    v_writelane_b32 v20, s54, 6
    v_writelane_b32 v20, s55, 7
    v_writelane_b32 v20, s56, 8
    v_writelane_b32 v20, s57, 9
    v_writelane_b32 v20, s58, 10
    v_writelane_b32 v20, s59, 11
    v_writelane_b32 v20, s60, 12
    v_writelane_b32 v20, s61, 13
    v_writelane_b32 v20, s62, 14
    v_writelane_b32 v20, s63, 15
    v_writelane_b32 v20, s64, 16
    v_writelane_b32 v20, s65, 17
    v_writelane_b32 v20, s66, 18
    v_writelane_b32 v20, s67, 19
    v_writelane_b32 v20, s68, 20
    v_writelane_b32 v20, s69, 21
    v_writelane_b32 v20, s70, 22
    v_writelane_b32 v20, s71, 23
    v_writelane_b32 v20, s72, 24
    v_writelane_b32 v20, s73, 25
    v_writelane_b32 v20, s74, 26
    v_writelane_b32 v20, s75, 27
    v_writelane_b32 v20, s76, 28
    v_writelane_b32 v20, s77, 29
    v_writelane_b32 v20, s78, 30
    v_writelane_b32 v20, s79, 31
    v_and_b32 v21, 3, v1
    v_lshlrev_b32 v21, 2, v21
    v_bfe_u32 v22, v1, 2, 2
    v_add_u32 v21, v21, v22
    v_and_b32 v22, 16, v1
    v_add_u32 v21, v21, v22
    v_lshlrev_b32 v21, 2, v21
    s_lshl_b32 s38, s3, 7
    v_add_u32 v21, s38, v21
    s_mov_b64 exec, 0xffffffff
    ds_write_b32 v21, v20 offset:384
    s_mov_b64 exec, -1
    s_mov_b32 s44, s34
    s_mov_b32 s45, s35
    s_mov_b32 s46, 1073741824
    s_mov_b32 s47, 0x20000
    v_mov_b32 v7, 0
    v_mov_b32 v6, 1
    s_mov_b64 s[62:63], exec
    s_mov_b64 exec, 1
    ds_add_u32 v7, v6 offset:0
    s_mov_b64 exec, s[62:63]
    s_branch L_exit
L_kvF0:
    s_mov_b32 s53, 11
    s_branch L_kvFgo
L_kvF:
    s_sub_u32 s53, s3, 5
L_kvFgo:
    s_sub_u32 s52, s5, 7
    s_mul_i32 s52, s52, 24
    s_add_u32 s52, s52, 40
    s_lshl_b32 s54, s53, 1
    s_add_u32 s52, s52, s54
    s_lshl_b32 s52, s52, 12
    s_lshl_b32 s54, s4, 24
    s_add_u32 s52, s52, s54
    s_add_u32 s52, s52, 15728640
    s_add_u32 s55, s52, 4096
    s_mov_b32 s36, s10
    s_mov_b32 s37, s11
    s_mov_b32 s38, 268435456
    s_mov_b32 s39, 0x20000
    s_mov_b32 s40, s12
    s_mov_b32 s41, s13
    s_mov_b32 s42, 268435456
    s_mov_b32 s43, 0x20000
    v_and_b32 v4, 7, v1
    v_lshlrev_b32 v4, 8, v4
    v_lshrrev_b32 v5, 3, v1
    v_lshl_add_u32 v4, v5, 4, v4
    v_lshlrev_b32 v5, 10, v3
    v_lshl_add_u32 v5, v2, 4, v5
    buffer_load_dwordx4 v[32:35], v4, s[36:39], s52 offen offset:0 nt
    s_barrier
    buffer_load_dwordx4 v[36:39], v4, s[36:39], s52 offen offset:128 nt
    buffer_load_dwordx4 v[40:43], v4, s[36:39], s52 offen offset:2048 nt
    buffer_load_dwordx4 v[44:47], v4, s[36:39], s52 offen offset:2176 nt
    buffer_load_dwordx4 v[48:51], v4, s[36:39], s55 offen offset:0 nt
    buffer_load_dwordx4 v[52:55], v4, s[36:39], s55 offen offset:128 nt
    buffer_load_dwordx4 v[56:59], v4, s[36:39], s55 offen offset:2048 nt
    buffer_load_dwordx4 v[60:63], v4, s[36:39], s55 offen offset:2176 nt
    v_mov_b32 v7, 0
    v_mov_b32 v6, 1
    s_mov_b64 s[62:63], exec
    s_mov_b64 exec, 1
    ds_add_u32 v7, v6 offset:32
    s_mov_b64 exec, s[62:63]
    v_mov_b32 v7, 0
    s_mov_b32 s61, 0x400000
Lw_19:
    ds_read_b32 v6, v7 offset:32
    s_waitcnt lgkmcnt(0)
    v_readfirstlane_b32 s60, v6
    s_nop 2
    s_cmp_ge_u32 s60, 12
    s_cbranch_scc1 Ld_20
    s_sub_u32 s61, s61, 1
    s_cbranch_scc1 L_abort
    s_sleep 1
    s_branch Lw_19
Ld_20:
    buffer_load_dwordx4 v[64:67], v5, s[40:43], s52 offen offset:0 nt
    buffer_load_dwordx4 v[68:71], v5, s[40:43], s52 offen offset:256 nt
    buffer_load_dwordx4 v[72:75], v5, s[40:43], s52 offen offset:512 nt
    buffer_load_dwordx4 v[76:79], v5, s[40:43], s52 offen offset:768 nt
    buffer_load_dwordx4 v[80:83], v5, s[40:43], s55 offen offset:0 nt
    buffer_load_dwordx4 v[84:87], v5, s[40:43], s55 offen offset:256 nt
    buffer_load_dwordx4 v[88:91], v5, s[40:43], s55 offen offset:512 nt
    buffer_load_dwordx4 v[92:95], v5, s[40:43], s55 offen offset:768 nt
    v_mov_b32 v7, 0
    v_mov_b32 v6, 1
    s_mov_b64 s[62:63], exec
    s_mov_b64 exec, 1
    ds_add_u32 v7, v6 offset:4
    s_mov_b64 exec, s[62:63]
    v_and_b32 v6, 1, v2
    v_lshlrev_b32 v6, 4, v6
    v_mov_b32 v7, 0xffff
    v_lshlrev_b32 v7, v6, v7
    v_bfe_u32 v6, v2, 1, 2
    v_cmp_eq_u32 vcc, 0, v6
    s_nop 1
    v_cndmask_b32 v8, 0, v7, vcc
    v_cmp_eq_u32 vcc, 1, v6
    s_nop 1
    v_cndmask_b32 v9, 0, v7, vcc
    v_cmp_eq_u32 vcc, 2, v6
    s_nop 1
    v_cndmask_b32 v10, 0, v7, vcc
    v_cmp_eq_u32 vcc, 3, v6
    s_nop 1
    v_cndmask_b32 v11, 0, v7, vcc
    v_bfe_u32 v12, v2, 2, 1
    v_lshlrev_b32 v22, 2, v12
    v_lshlrev_b32 v12, 8, v12
    v_lshrrev_b32 v13, 3, v2
    v_lshl_add_u32 v13, v3, 1, v13
    v_lshl_add_u32 v12, v13, 4, v12
    v_add_u32 v12, 512, v12
    v_and_b32 v13, 3, v2
    v_mov_b32 v14, 256
    v_cmp_eq_u32 vcc, 0, v13
    s_nop 1
    v_cndmask_b32 v16, v14, v12, vcc
    v_cmp_eq_u32 vcc, 1, v13
    s_nop 1
    v_cndmask_b32 v17, v14, v12, vcc
    v_cmp_eq_u32 vcc, 2, v13
    s_nop 1
    v_cndmask_b32 v18, v14, v12, vcc
    v_cmp_eq_u32 vcc, 3, v13
    s_nop 1
    v_cndmask_b32 v19, v14, v12, vcc
    v_and_b32 v12, 1, v3
    v_lshlrev_b32 v12, 4, v12
    v_lshrrev_b32 v13, 3, v2
    v_lshl_add_u32 v12, v13, 2, v12
    v_lshrrev_b32 v13, 1, v3
    v_add_u32 v12, v12, v13
    v_lshlrev_b32 v20, 2, v12
    v_add_u32 v21, 8, v20
    s_waitcnt lgkmcnt(0)
    s_add_u32 s6, s6, 0x7f4a7c15
    s_add_u32 s7, s7, 0x9e3779b9
    v_mov_b32 v7, 0
    s_mov_b32 s61, 0x400000
Lw_21:
    ds_read_b32 v6, v7 offset:0
    s_waitcnt lgkmcnt(0)
    v_readfirstlane_b32 s60, v6
    s_nop 2
    s_cmp_ge_u32 s60, 4
    s_cbranch_scc1 Ld_22
    s_sub_u32 s61, s61, 1
    s_cbranch_scc1 L_abort
    s_sleep 2
    s_branch Lw_21
Ld_22:
    s_waitcnt vmcnt(16)
    ds_read_b128 v[96:99], v16 offset:0
    ds_read_b128 v[100:103], v16 offset:128
    ds_read_b128 v[104:107], v17 offset:0
    ds_read_b128 v[108:111], v17 offset:128
    ds_read_b128 v[112:115], v18 offset:0
    ds_read_b128 v[116:119], v18 offset:128
    ds_read_b128 v[120:123], v19 offset:0
    ds_read_b128 v[124:127], v19 offset:128
    s_waitcnt vmcnt(8)
    s_waitcnt lgkmcnt(7)
    v_mfma_f32_16x16x32_bf16 v[24:27], v[32:35], v[96:99], 0
    s_waitcnt lgkmcnt(6)
    v_mfma_f32_16x16x32_bf16 v[24:27], v[36:39], v[100:103], v[24:27]
    s_waitcnt lgkmcnt(5)
    v_mfma_f32_16x16x32_bf16 v[24:27], v[40:43], v[104:107], v[24:27]
    s_waitcnt lgkmcnt(4)
    v_mfma_f32_16x16x32_bf16 v[24:27], v[44:47], v[108:111], v[24:27]
    s_waitcnt lgkmcnt(3)
    v_mfma_f32_16x16x32_bf16 v[24:27], v[48:51], v[112:115], v[24:27]
    s_waitcnt lgkmcnt(2)
    v_mfma_f32_16x16x32_bf16 v[24:27], v[52:55], v[116:119], v[24:27]
    s_waitcnt lgkmcnt(1)
    v_mfma_f32_16x16x32_bf16 v[24:27], v[56:59], v[120:123], v[24:27]
    s_waitcnt lgkmcnt(0)
    v_mfma_f32_16x16x32_bf16 v[24:27], v[60:63], v[124:127], v[24:27]
    s_nop 7
    v_mov_b32 v28, v24
    v_mov_b32 v29, v25
    v_mov_b32 v30, v26
    v_mov_b32 v31, v27
    v_permlane32_swap_b32 v24, v28
    v_permlane32_swap_b32 v25, v29
    v_permlane32_swap_b32 v26, v30
    v_permlane32_swap_b32 v27, v31
    v_add_f32_dpp v24, v28, v24 row_shl:8 row_mask:0xf bank_mask:0xf
    v_add_f32_dpp v25, v29, v25 row_shl:8 row_mask:0xf bank_mask:0xf
    v_add_f32_dpp v26, v30, v26 row_shl:8 row_mask:0xf bank_mask:0xf
    v_add_f32_dpp v27, v31, v27 row_shl:8 row_mask:0xf bank_mask:0xf
    s_mov_b32 s56, 0x3db504f3
    s_mov_b32 s57, 0xffff0000
    s_mov_b32 s58, 0x3fb8aa3b
    v_cvt_pk_bf16_f32 v28, v24, v25
    v_cvt_pk_bf16_f32 v29, v26, v27
    v_lshlrev_b32 v24, 16, v28
    v_and_b32 v25, s57, v28
    v_lshlrev_b32 v26, 16, v29
    v_and_b32 v27, s57, v29
    v_mul_f32 v24, s56, v24
    v_mul_f32 v25, s56, v25
    v_mul_f32 v26, s56, v26
    v_mul_f32 v27, s56, v27
    v_cvt_pk_bf16_f32 v28, v24, v25
    v_cvt_pk_bf16_f32 v29, v26, v27
    v_lshlrev_b32 v24, 16, v28
    v_and_b32 v25, s57, v28
    v_lshlrev_b32 v26, 16, v29
    v_and_b32 v27, s57, v29
    v_max3_f32 v12, v24, v25, v26
    v_max_f32 v12, v12, v27
    s_nop 1
    v_max_f32_dpp v12, v12, v12 quad_perm:[1,0,3,2] row_mask:0xf bank_mask:0xf
    s_nop 1
    v_max_f32_dpp v12, v12, v12 quad_perm:[2,3,0,1] row_mask:0xf bank_mask:0xf
    v_mov_b32 v13, v12
    s_nop 1
    v_permlane16_swap_b32 v12, v13
    v_max_f32 v12, v12, v13
    s_lshl_b32 s59, s53, 3
    v_add_u32 v23, s59, v22
    s_mov_b64 s[62:63], exec
    s_mov_b64 exec, 0x11
    ds_write_b32 v23, v12 offset:1024
    s_mov_b64 exec, s[62:63]
    v_mov_b32 v15, v12
    v_mul_f32 v13, s58, v15
    v_fma_f32 v24, v24, s58, -v13
    v_fma_f32 v25, v25, s58, -v13
    v_fma_f32 v26, v26, s58, -v13
    v_fma_f32 v27, v27, s58, -v13
    v_exp_f32 v24, v24
    v_exp_f32 v25, v25
    v_exp_f32 v26, v26
    v_exp_f32 v27, v27
    v_add_f32 v12, v24, v25
    v_add_f32 v13, v26, v27
    v_cvt_pk_bf16_f32 v24, v24, v24
    v_cvt_pk_bf16_f32 v25, v25, v25
    v_cvt_pk_bf16_f32 v26, v26, v26
    v_cvt_pk_bf16_f32 v27, v27, v27
    v_add_f32 v12, v12, v13
    ds_bpermute_b32 v104, v20, v24
    ds_bpermute_b32 v105, v20, v25
    ds_bpermute_b32 v106, v20, v26
    ds_bpermute_b32 v107, v20, v27
    ds_bpermute_b32 v108, v21, v24
    ds_bpermute_b32 v109, v21, v25
    ds_bpermute_b32 v110, v21, v26
    ds_bpermute_b32 v111, v21, v27
    v_add_f32_dpp v12, v12, v12 quad_perm:[1,0,3,2] row_mask:0xf bank_mask:0xf
    s_nop 1
    v_add_f32_dpp v12, v12, v12 quad_perm:[2,3,0,1] row_mask:0xf bank_mask:0xf
    v_mov_b32 v13, v12
    s_nop 1
    v_permlane16_swap_b32 v12, v13
    v_add_f32 v12, v12, v13
    s_mov_b64 s[62:63], exec
    s_mov_b64 exec, 0x11
    ds_write_b32 v23, v12 offset:1152
    s_mov_b64 exec, s[62:63]
    s_waitcnt lgkmcnt(1)
    v_and_b32 v32, v104, v8
    v_and_b32 v33, v104, v9
    v_and_b32 v34, v104, v10
    v_and_b32 v35, v104, v11
    v_and_b32 v36, v105, v8
    v_and_b32 v37, v105, v9
    v_and_b32 v38, v105, v10
    v_and_b32 v39, v105, v11
    v_and_b32 v40, v106, v8
    v_and_b32 v41, v106, v9
    v_and_b32 v42, v106, v10
    v_and_b32 v43, v106, v11
    v_and_b32 v44, v107, v8
    v_and_b32 v45, v107, v9
    v_and_b32 v46, v107, v10
    v_and_b32 v47, v107, v11
    v_and_b32 v48, v108, v8
    v_and_b32 v49, v108, v9
    v_and_b32 v50, v108, v10
    v_and_b32 v51, v108, v11
    v_and_b32 v52, v109, v8
    v_and_b32 v53, v109, v9
    v_and_b32 v54, v109, v10
    v_and_b32 v55, v109, v11
    v_and_b32 v56, v110, v8
    v_and_b32 v57, v110, v9
    v_and_b32 v58, v110, v10
    v_and_b32 v59, v110, v11
    v_and_b32 v60, v111, v8
    v_and_b32 v61, v111, v9
    v_and_b32 v62, v111, v10
    v_and_b32 v63, v111, v11
    v_mov_b32 v114, s6
    v_mov_b32 v115, s7
    v_mov_b32 v118, s6
    v_mov_b32 v119, s7
    v_mov_b32 v122, s6
    v_mov_b32 v123, s7
    s_waitcnt vmcnt(0)
    v_mfma_f32_16x16x32_bf16 v[96:99], v[64:67], v[32:35], 0
    v_mfma_f32_16x16x32_bf16 v[96:99], v[68:71], v[36:39], v[96:99]
    v_mfma_f32_16x16x32_bf16 v[96:99], v[72:75], v[40:43], v[96:99]
    v_mfma_f32_16x16x32_bf16 v[96:99], v[76:79], v[44:47], v[96:99]
    v_mfma_f32_16x16x32_bf16 v[96:99], v[80:83], v[48:51], v[96:99]
    v_mfma_f32_16x16x32_bf16 v[96:99], v[84:87], v[52:55], v[96:99]
    v_mfma_f32_16x16x32_bf16 v[96:99], v[88:91], v[56:59], v[96:99]
    v_mfma_f32_16x16x32_bf16 v[96:99], v[92:95], v[60:63], v[96:99]
    s_lshl_b32 s59, s53, 10
    v_lshlrev_b32 v16, 4, v1
    v_add_u32 v17, s59, v16
    s_nop 4
    ds_write_b128 v17, v[96:99] offset:23040
    v_mov_b32 v7, 0
    v_mov_b32 v6, 1
    s_mov_b64 s[62:63], exec
    s_mov_b64 exec, 1
    ds_add_rtn_u32 v6, v7, v6 offset:12
    s_waitcnt lgkmcnt(0)
    v_readfirstlane_b32 s60, v6
    s_mov_b64 exec, s[62:63]
    s_nop 1
    s_cmp_lg_u32 s60, 11
    s_cbranch_scc1 Lkvdone_23
    v_lshlrev_b32 v18, 3, v1
    ds_read_b64 v[32:33], v18 offset:23040
    ds_read_b64 v[34:35], v18 offset:23552
    ds_read_b64 v[36:37], v18 offset:24064
    ds_read_b64 v[38:39], v18 offset:24576
    ds_read_b64 v[40:41], v18 offset:25088
    ds_read_b64 v[42:43], v18 offset:25600
    ds_read_b64 v[44:45], v18 offset:26112
    ds_read_b64 v[46:47], v18 offset:26624
    ds_read_b64 v[48:49], v18 offset:27136
    ds_read_b64 v[50:51], v18 offset:27648
    ds_read_b64 v[52:53], v18 offset:28160
    ds_read_b64 v[54:55], v18 offset:28672
    ds_read_b64 v[56:57], v18 offset:29184
    ds_read_b64 v[58:59], v18 offset:29696
    ds_read_b64 v[60:61], v18 offset:30208
    ds_read_b64 v[62:63], v18 offset:30720
    ds_read_b64 v[64:65], v18 offset:31232
    ds_read_b64 v[66:67], v18 offset:31744
    ds_read_b64 v[68:69], v18 offset:32256
    ds_read_b64 v[70:71], v18 offset:32768
    ds_read_b64 v[72:73], v18 offset:33280
    ds_read_b64 v[74:75], v18 offset:33792
    ds_read_b64 v[76:77], v18 offset:34304
    ds_read_b64 v[78:79], v18 offset:34816
    v_bfe_u32 v19, v1, 4, 1
    v_lshlrev_b32 v21, 2, v19
    v_lshlrev_b32 v17, 6, v19
    v_and_b32 v19, 3, v1
    v_lshl_add_u32 v17, v19, 4, v17
    ds_read_b32 v84, v21 offset:1024
    ds_read_b32 v85, v21 offset:1032
    ds_read_b32 v86, v21 offset:1040
    ds_read_b32 v87, v21 offset:1048
    ds_read_b32 v88, v21 offset:1056
    ds_read_b32 v89, v21 offset:1064
    ds_read_b32 v90, v21 offset:1072
    ds_read_b32 v91, v21 offset:1080
    ds_read_b32 v92, v21 offset:1088
    ds_read_b32 v93, v21 offset:1096
    ds_read_b32 v94, v21 offset:1104
    ds_read_b32 v95, v21 offset:1112
    ds_read_b32 v100, v21 offset:1152
    ds_read_b32 v101, v21 offset:1160
    ds_read_b32 v102, v21 offset:1168
    ds_read_b32 v103, v21 offset:1176
    ds_read_b32 v104, v21 offset:1184
    ds_read_b32 v105, v21 offset:1192
    ds_read_b32 v106, v21 offset:1200
    ds_read_b32 v107, v21 offset:1208
    ds_read_b32 v108, v21 offset:1216
    ds_read_b32 v109, v21 offset:1224
    ds_read_b32 v110, v21 offset:1232
    ds_read_b32 v111, v21 offset:1240
    s_lshl_b32 s59, s4, 4
    s_add_u32 s59, s59, s5
    s_mul_i32 s59, s59, 2560
    s_add_u32 s59, s59, 262144
    s_waitcnt lgkmcnt(0)
    v_mov_b32 v15, v84
    v_max3_f32 v15, v15, v85, v86
    v_max3_f32 v15, v15, v87, v88
    v_max3_f32 v15, v15, v89, v90
    v_max3_f32 v15, v15, v91, v92
    v_max3_f32 v15, v15, v93, v94
    v_max_f32 v15, v15, v95
    v_mul_f32 v13, s58, v15
    v_fma_f32 v84, v84, s58, -v13
    v_fma_f32 v85, v85, s58, -v13
    v_fma_f32 v86, v86, s58, -v13
    v_fma_f32 v87, v87, s58, -v13
    v_fma_f32 v88, v88, s58, -v13
    v_fma_f32 v89, v89, s58, -v13
    v_fma_f32 v90, v90, s58, -v13
    v_fma_f32 v91, v91, s58, -v13
    v_fma_f32 v92, v92, s58, -v13
    v_fma_f32 v93, v93, s58, -v13
    v_fma_f32 v94, v94, s58, -v13
    v_fma_f32 v95, v95, s58, -v13
    v_exp_f32 v84, v84
    v_exp_f32 v85, v85
    v_exp_f32 v86, v86
    v_exp_f32 v87, v87
    v_exp_f32 v88, v88
    v_exp_f32 v89, v89
    v_exp_f32 v90, v90
    v_exp_f32 v91, v91
    v_exp_f32 v92, v92
    v_exp_f32 v93, v93
    v_exp_f32 v94, v94
    v_exp_f32 v95, v95
    v_mul_f32 v32, v32, v84
    v_mul_f32 v33, v33, v84
    v_mul_f32 v34, v34, v84
    v_mul_f32 v35, v35, v84
    v_mul_f32 v100, v100, v84
    v_mul_f32 v36, v36, v85
    v_mul_f32 v37, v37, v85
    v_mul_f32 v38, v38, v85
    v_mul_f32 v39, v39, v85
    v_mul_f32 v101, v101, v85
    v_fmac_f32 v32, v40, v86
    v_fmac_f32 v33, v41, v86
    v_fmac_f32 v34, v42, v86
    v_fmac_f32 v35, v43, v86
    v_fmac_f32 v100, v102, v86
    v_fmac_f32 v36, v44, v87
    v_fmac_f32 v37, v45, v87
    v_fmac_f32 v38, v46, v87
    v_fmac_f32 v39, v47, v87
    v_fmac_f32 v101, v103, v87
    v_fmac_f32 v32, v48, v88
    v_fmac_f32 v33, v49, v88
    v_fmac_f32 v34, v50, v88
    v_fmac_f32 v35, v51, v88
    v_fmac_f32 v100, v104, v88
    v_fmac_f32 v36, v52, v89
    v_fmac_f32 v37, v53, v89
    v_fmac_f32 v38, v54, v89
    v_fmac_f32 v39, v55, v89
    v_fmac_f32 v101, v105, v89
    v_fmac_f32 v32, v56, v90
    v_fmac_f32 v33, v57, v90
    v_fmac_f32 v34, v58, v90
    v_fmac_f32 v35, v59, v90
    v_fmac_f32 v100, v106, v90
    v_fmac_f32 v36, v60, v91
    v_fmac_f32 v37, v61, v91
    v_fmac_f32 v38, v62, v91
    v_fmac_f32 v39, v63, v91
    v_fmac_f32 v101, v107, v91
    v_fmac_f32 v32, v64, v92
    v_fmac_f32 v33, v65, v92
    v_fmac_f32 v34, v66, v92
    v_fmac_f32 v35, v67, v92
    v_fmac_f32 v100, v108, v92
    v_fmac_f32 v36, v68, v93
    v_fmac_f32 v37, v69, v93
    v_fmac_f32 v38, v70, v93
    v_fmac_f32 v39, v71, v93
    v_fmac_f32 v101, v109, v93
    v_fmac_f32 v32, v72, v94
    v_fmac_f32 v33, v73, v94
    v_fmac_f32 v34, v74, v94
    v_fmac_f32 v35, v75, v94
    v_fmac_f32 v100, v110, v94
    v_fmac_f32 v36, v76, v95
    v_fmac_f32 v37, v77, v95
    v_fmac_f32 v38, v78, v95
    v_fmac_f32 v39, v79, v95
    v_fmac_f32 v101, v111, v95
    v_add_f32 v32, v32, v36
    v_add_f32 v33, v33, v37
    v_add_f32 v34, v34, v38
    v_add_f32 v35, v35, v39
    v_add_f32 v100, v100, v101
    v_mov_b32 v112, v32
    v_mov_b32 v113, v33
    v_mov_b32 v116, v34
    v_mov_b32 v117, v35
    v_mov_b32 v120, v15
    v_mov_b32 v121, v100
    s_add_u32 s65, s59, 1900544
    buffer_store_dwordx4 v[112:115], v16, s[44:47], s65 offen
    buffer_store_dwordx4 v[116:119], v16, s[44:47], s65 offen offset:1024
    s_mov_b64 exec, 0x000f000f
    buffer_store_dwordx4 v[120:123], v17, s[44:47], s65 offen offset:2048
    s_mov_b64 exec, -1
    buffer_store_dwordx4 v[112:115], v16, s[44:47], s59 offen sc1
    buffer_store_dwordx4 v[116:119], v16, s[44:47], s59 offen offset:1024 sc1
    s_mov_b64 exec, 0x000f000f
    buffer_store_dwordx4 v[120:123], v17, s[44:47], s59 offen offset:2048 sc1
    s_mov_b64 exec, -1
    v_mov_b32 v7, 0
    v_mov_b32 v6, 1
    s_mov_b64 s[62:63], exec
    s_mov_b64 exec, 1
    ds_add_u32 v7, v6 offset:28
    s_mov_b64 exec, s[62:63]
Lkvdone_23:
    s_cmp_lt_u32 s53, 5
    s_cbranch_scc1 L_down
    s_cmp_eq_u32 s53, 5
    s_cbranch_scc1 L_commF
    s_branch L_exit
L_kvM:
    s_sub_u32 s53, s3, 12
    s_mul_i32 s52, s5, 8
    s_lshl_b32 s54, s53, 1
    s_add_u32 s52, s52, s54
    s_lshl_b32 s52, s52, 12
    s_lshl_b32 s54, s4, 24
    s_add_u32 s52, s52, s54
    s_add_u32 s52, s52, 15728640
    s_add_u32 s55, s52, 4096
    s_mov_b32 s36, s10
    s_mov_b32 s37, s11
    s_mov_b32 s38, 268435456
    s_mov_b32 s39, 0x20000
    s_mov_b32 s40, s12
    s_mov_b32 s41, s13
    s_mov_b32 s42, 268435456
    s_mov_b32 s43, 0x20000
    v_and_b32 v4, 7, v1
    v_lshlrev_b32 v4, 8, v4
    v_lshrrev_b32 v5, 3, v1
    v_lshl_add_u32 v4, v5, 4, v4
    v_lshlrev_b32 v5, 10, v3
    v_lshl_add_u32 v5, v2, 4, v5
    s_barrier
    v_mov_b32 v7, 0
    s_mov_b32 s61, 0x400000
Lw_24:
    ds_read_b32 v6, v7 offset:44
    s_waitcnt lgkmcnt(0)
    v_readfirstlane_b32 s60, v6
    s_nop 2
    s_cmp_ge_u32 s60, 6
    s_cbranch_scc1 Ld_25
    s_sub_u32 s61, s61, 1
    s_cbranch_scc1 L_abort
    s_sleep 2
    s_branch Lw_24
Ld_25:
    buffer_load_dwordx4 v[32:35], v4, s[36:39], s52 offen offset:0 nt
    buffer_load_dwordx4 v[36:39], v4, s[36:39], s52 offen offset:128 nt
    buffer_load_dwordx4 v[40:43], v4, s[36:39], s52 offen offset:2048 nt
    buffer_load_dwordx4 v[44:47], v4, s[36:39], s52 offen offset:2176 nt
    buffer_load_dwordx4 v[48:51], v4, s[36:39], s55 offen offset:0 nt
    buffer_load_dwordx4 v[52:55], v4, s[36:39], s55 offen offset:128 nt
    buffer_load_dwordx4 v[56:59], v4, s[36:39], s55 offen offset:2048 nt
    buffer_load_dwordx4 v[60:63], v4, s[36:39], s55 offen offset:2176 nt
    v_mov_b32 v7, 0
    v_mov_b32 v6, 1
    s_mov_b64 s[62:63], exec
    s_mov_b64 exec, 1
    ds_add_u32 v7, v6 offset:32
    s_mov_b64 exec, s[62:63]
    v_mov_b32 v7, 0
    s_mov_b32 s61, 0x400000
Lw_26:
    ds_read_b32 v6, v7 offset:32
    s_waitcnt lgkmcnt(0)
    v_readfirstlane_b32 s60, v6
    s_nop 2
    s_cmp_ge_u32 s60, 4
    s_cbranch_scc1 Ld_27
    s_sub_u32 s61, s61, 1
    s_cbranch_scc1 L_abort
    s_sleep 1
    s_branch Lw_26
Ld_27:
    buffer_load_dwordx4 v[64:67], v5, s[40:43], s52 offen offset:0 nt
    buffer_load_dwordx4 v[68:71], v5, s[40:43], s52 offen offset:256 nt
    buffer_load_dwordx4 v[72:75], v5, s[40:43], s52 offen offset:512 nt
    buffer_load_dwordx4 v[76:79], v5, s[40:43], s52 offen offset:768 nt
    buffer_load_dwordx4 v[80:83], v5, s[40:43], s55 offen offset:0 nt
    buffer_load_dwordx4 v[84:87], v5, s[40:43], s55 offen offset:256 nt
    buffer_load_dwordx4 v[88:91], v5, s[40:43], s55 offen offset:512 nt
    buffer_load_dwordx4 v[92:95], v5, s[40:43], s55 offen offset:768 nt
    v_mov_b32 v7, 0
    v_mov_b32 v6, 1
    s_mov_b64 s[62:63], exec
    s_mov_b64 exec, 1
    ds_add_u32 v7, v6 offset:4
    s_mov_b64 exec, s[62:63]
    v_and_b32 v6, 1, v2
    v_lshlrev_b32 v6, 4, v6
    v_mov_b32 v7, 0xffff
    v_lshlrev_b32 v7, v6, v7
    v_bfe_u32 v6, v2, 1, 2
    v_cmp_eq_u32 vcc, 0, v6
    s_nop 1
    v_cndmask_b32 v8, 0, v7, vcc
    v_cmp_eq_u32 vcc, 1, v6
    s_nop 1
    v_cndmask_b32 v9, 0, v7, vcc
    v_cmp_eq_u32 vcc, 2, v6
    s_nop 1
    v_cndmask_b32 v10, 0, v7, vcc
    v_cmp_eq_u32 vcc, 3, v6
    s_nop 1
    v_cndmask_b32 v11, 0, v7, vcc
    v_bfe_u32 v12, v2, 2, 1
    v_lshlrev_b32 v22, 2, v12
    v_lshlrev_b32 v12, 8, v12
    v_lshrrev_b32 v13, 3, v2
    v_lshl_add_u32 v13, v3, 1, v13
    v_lshl_add_u32 v12, v13, 4, v12
    v_add_u32 v12, 512, v12
    v_and_b32 v13, 3, v2
    v_mov_b32 v14, 256
    v_cmp_eq_u32 vcc, 0, v13
    s_nop 1
    v_cndmask_b32 v16, v14, v12, vcc
    v_cmp_eq_u32 vcc, 1, v13
    s_nop 1
    v_cndmask_b32 v17, v14, v12, vcc
    v_cmp_eq_u32 vcc, 2, v13
    s_nop 1
    v_cndmask_b32 v18, v14, v12, vcc
    v_cmp_eq_u32 vcc, 3, v13
    s_nop 1
    v_cndmask_b32 v19, v14, v12, vcc
    v_and_b32 v12, 1, v3
    v_lshlrev_b32 v12, 4, v12
    v_lshrrev_b32 v13, 3, v2
    v_lshl_add_u32 v12, v13, 2, v12
    v_lshrrev_b32 v13, 1, v3
    v_add_u32 v12, v12, v13
    v_lshlrev_b32 v20, 2, v12
    v_add_u32 v21, 8, v20
    s_waitcnt lgkmcnt(0)
    s_add_u32 s6, s6, 0x7f4a7c15
    s_add_u32 s7, s7, 0x9e3779b9
    v_mov_b32 v7, 0
    s_mov_b32 s61, 0x400000
Lw_28:
    ds_read_b32 v6, v7 offset:0
    s_waitcnt lgkmcnt(0)
    v_readfirstlane_b32 s60, v6
    s_nop 2
    s_cmp_ge_u32 s60, 4
    s_cbranch_scc1 Ld_29
    s_sub_u32 s61, s61, 1
    s_cbranch_scc1 L_abort
    s_sleep 2
    s_branch Lw_28
Ld_29:
    s_waitcnt vmcnt(16)
    ds_read_b128 v[96:99], v16 offset:0
    ds_read_b128 v[100:103], v16 offset:128
    ds_read_b128 v[104:107], v17 offset:0
    ds_read_b128 v[108:111], v17 offset:128
    ds_read_b128 v[112:115], v18 offset:0
    ds_read_b128 v[116:119], v18 offset:128
    ds_read_b128 v[120:123], v19 offset:0
    ds_read_b128 v[124:127], v19 offset:128
    s_waitcnt vmcnt(8)
    s_waitcnt lgkmcnt(7)
    v_mfma_f32_16x16x32_bf16 v[24:27], v[32:35], v[96:99], 0
    s_waitcnt lgkmcnt(6)
    v_mfma_f32_16x16x32_bf16 v[24:27], v[36:39], v[100:103], v[24:27]
    s_waitcnt lgkmcnt(5)
    v_mfma_f32_16x16x32_bf16 v[24:27], v[40:43], v[104:107], v[24:27]
    s_waitcnt lgkmcnt(4)
    v_mfma_f32_16x16x32_bf16 v[24:27], v[44:47], v[108:111], v[24:27]
    s_waitcnt lgkmcnt(3)
    v_mfma_f32_16x16x32_bf16 v[24:27], v[48:51], v[112:115], v[24:27]
    s_waitcnt lgkmcnt(2)
    v_mfma_f32_16x16x32_bf16 v[24:27], v[52:55], v[116:119], v[24:27]
    s_waitcnt lgkmcnt(1)
    v_mfma_f32_16x16x32_bf16 v[24:27], v[56:59], v[120:123], v[24:27]
    s_waitcnt lgkmcnt(0)
    v_mfma_f32_16x16x32_bf16 v[24:27], v[60:63], v[124:127], v[24:27]
    s_nop 7
    v_mov_b32 v28, v24
    v_mov_b32 v29, v25
    v_mov_b32 v30, v26
    v_mov_b32 v31, v27
    v_permlane32_swap_b32 v24, v28
    v_permlane32_swap_b32 v25, v29
    v_permlane32_swap_b32 v26, v30
    v_permlane32_swap_b32 v27, v31
    v_add_f32_dpp v24, v28, v24 row_shl:8 row_mask:0xf bank_mask:0xf
    v_add_f32_dpp v25, v29, v25 row_shl:8 row_mask:0xf bank_mask:0xf
    v_add_f32_dpp v26, v30, v26 row_shl:8 row_mask:0xf bank_mask:0xf
    v_add_f32_dpp v27, v31, v27 row_shl:8 row_mask:0xf bank_mask:0xf
    s_mov_b32 s56, 0x3db504f3
    s_mov_b32 s57, 0xffff0000
    s_mov_b32 s58, 0x3fb8aa3b
    v_cvt_pk_bf16_f32 v28, v24, v25
    v_cvt_pk_bf16_f32 v29, v26, v27
    v_lshlrev_b32 v24, 16, v28
    v_and_b32 v25, s57, v28
    v_lshlrev_b32 v26, 16, v29
    v_and_b32 v27, s57, v29
    v_mul_f32 v24, s56, v24
    v_mul_f32 v25, s56, v25
    v_mul_f32 v26, s56, v26
    v_mul_f32 v27, s56, v27
    v_cvt_pk_bf16_f32 v28, v24, v25
    v_cvt_pk_bf16_f32 v29, v26, v27
    v_lshlrev_b32 v24, 16, v28
    v_and_b32 v25, s57, v28
    v_lshlrev_b32 v26, 16, v29
    v_and_b32 v27, s57, v29
    v_max3_f32 v12, v24, v25, v26
    v_max_f32 v12, v12, v27
    s_nop 1
    v_max_f32_dpp v12, v12, v12 quad_perm:[1,0,3,2] row_mask:0xf bank_mask:0xf
    s_nop 1
    v_max_f32_dpp v12, v12, v12 quad_perm:[2,3,0,1] row_mask:0xf bank_mask:0xf
    v_mov_b32 v13, v12
    s_nop 1
    v_permlane16_swap_b32 v12, v13
    v_max_f32 v12, v12, v13
    s_lshl_b32 s59, s53, 3
    v_add_u32 v23, s59, v22
    s_mov_b64 s[62:63], exec
    s_mov_b64 exec, 0x11
    ds_write_b32 v23, v12 offset:1024
    s_mov_b64 exec, s[62:63]
    v_mov_b32 v15, v12
    v_mul_f32 v13, s58, v15
    v_fma_f32 v24, v24, s58, -v13
    v_fma_f32 v25, v25, s58, -v13
    v_fma_f32 v26, v26, s58, -v13
    v_fma_f32 v27, v27, s58, -v13
    v_exp_f32 v24, v24
    v_exp_f32 v25, v25
    v_exp_f32 v26, v26
    v_exp_f32 v27, v27
    v_add_f32 v12, v24, v25
    v_add_f32 v13, v26, v27
    v_cvt_pk_bf16_f32 v24, v24, v24
    v_cvt_pk_bf16_f32 v25, v25, v25
    v_cvt_pk_bf16_f32 v26, v26, v26
    v_cvt_pk_bf16_f32 v27, v27, v27
    v_add_f32 v12, v12, v13
    ds_bpermute_b32 v104, v20, v24
    ds_bpermute_b32 v105, v20, v25
    ds_bpermute_b32 v106, v20, v26
    ds_bpermute_b32 v107, v20, v27
    ds_bpermute_b32 v108, v21, v24
    ds_bpermute_b32 v109, v21, v25
    ds_bpermute_b32 v110, v21, v26
    ds_bpermute_b32 v111, v21, v27
    v_add_f32_dpp v12, v12, v12 quad_perm:[1,0,3,2] row_mask:0xf bank_mask:0xf
    s_nop 1
    v_add_f32_dpp v12, v12, v12 quad_perm:[2,3,0,1] row_mask:0xf bank_mask:0xf
    v_mov_b32 v13, v12
    s_nop 1
    v_permlane16_swap_b32 v12, v13
    v_add_f32 v12, v12, v13
    s_mov_b64 s[62:63], exec
    s_mov_b64 exec, 0x11
    ds_write_b32 v23, v12 offset:1152
    s_mov_b64 exec, s[62:63]
    s_waitcnt lgkmcnt(1)
    v_and_b32 v32, v104, v8
    v_and_b32 v33, v104, v9
    v_and_b32 v34, v104, v10
    v_and_b32 v35, v104, v11
    v_and_b32 v36, v105, v8
    v_and_b32 v37, v105, v9
    v_and_b32 v38, v105, v10
    v_and_b32 v39, v105, v11
    v_and_b32 v40, v106, v8
    v_and_b32 v41, v106, v9
    v_and_b32 v42, v106, v10
    v_and_b32 v43, v106, v11
    v_and_b32 v44, v107, v8
    v_and_b32 v45, v107, v9
    v_and_b32 v46, v107, v10
    v_and_b32 v47, v107, v11
    v_and_b32 v48, v108, v8
    v_and_b32 v49, v108, v9
    v_and_b32 v50, v108, v10
    v_and_b32 v51, v108, v11
    v_and_b32 v52, v109, v8
    v_and_b32 v53, v109, v9
    v_and_b32 v54, v109, v10
    v_and_b32 v55, v109, v11
    v_and_b32 v56, v110, v8
    v_and_b32 v57, v110, v9
    v_and_b32 v58, v110, v10
    v_and_b32 v59, v110, v11
    v_and_b32 v60, v111, v8
    v_and_b32 v61, v111, v9
    v_and_b32 v62, v111, v10
    v_and_b32 v63, v111, v11
    v_mov_b32 v114, s6
    v_mov_b32 v115, s7
    v_mov_b32 v118, s6
    v_mov_b32 v119, s7
    v_mov_b32 v122, s6
    v_mov_b32 v123, s7
    s_waitcnt vmcnt(0)
    v_mfma_f32_16x16x32_bf16 v[96:99], v[64:67], v[32:35], 0
    v_mfma_f32_16x16x32_bf16 v[96:99], v[68:71], v[36:39], v[96:99]
    v_mfma_f32_16x16x32_bf16 v[96:99], v[72:75], v[40:43], v[96:99]
    v_mfma_f32_16x16x32_bf16 v[96:99], v[76:79], v[44:47], v[96:99]
    v_mfma_f32_16x16x32_bf16 v[96:99], v[80:83], v[48:51], v[96:99]
    v_mfma_f32_16x16x32_bf16 v[96:99], v[84:87], v[52:55], v[96:99]
    v_mfma_f32_16x16x32_bf16 v[96:99], v[88:91], v[56:59], v[96:99]
    v_mfma_f32_16x16x32_bf16 v[96:99], v[92:95], v[60:63], v[96:99]
    s_lshl_b32 s59, s53, 10
    v_lshlrev_b32 v16, 4, v1
    v_add_u32 v17, s59, v16
    s_nop 4
    ds_write_b128 v17, v[96:99] offset:23040
    v_mov_b32 v7, 0
    v_mov_b32 v6, 1
    s_mov_b64 s[62:63], exec
    s_mov_b64 exec, 1
    ds_add_rtn_u32 v6, v7, v6 offset:12
    s_waitcnt lgkmcnt(0)
    v_readfirstlane_b32 s60, v6
    s_mov_b64 exec, s[62:63]
    s_nop 1
    s_cmp_lg_u32 s60, 3
    s_cbranch_scc1 Lkvdone_30
    v_lshlrev_b32 v18, 3, v1
    ds_read_b64 v[32:33], v18 offset:23040
    ds_read_b64 v[34:35], v18 offset:23552
    ds_read_b64 v[36:37], v18 offset:24064
    ds_read_b64 v[38:39], v18 offset:24576
    ds_read_b64 v[40:41], v18 offset:25088
    ds_read_b64 v[42:43], v18 offset:25600
    ds_read_b64 v[44:45], v18 offset:26112
    ds_read_b64 v[46:47], v18 offset:26624
    v_bfe_u32 v19, v1, 4, 1
    v_lshlrev_b32 v21, 2, v19
    v_lshlrev_b32 v17, 6, v19
    v_and_b32 v19, 3, v1
    v_lshl_add_u32 v17, v19, 4, v17
    ds_read_b32 v84, v21 offset:1024
    ds_read_b32 v85, v21 offset:1032
    ds_read_b32 v86, v21 offset:1040
    ds_read_b32 v87, v21 offset:1048
    ds_read_b32 v100, v21 offset:1152
    ds_read_b32 v101, v21 offset:1160
    ds_read_b32 v102, v21 offset:1168
    ds_read_b32 v103, v21 offset:1176
    s_lshl_b32 s59, s4, 4
    s_add_u32 s59, s59, s5
    s_mul_i32 s59, s59, 2560
    s_add_u32 s59, s59, 262144
    s_waitcnt lgkmcnt(0)
    v_mov_b32 v15, v84
    v_max3_f32 v15, v15, v85, v86
    v_max_f32 v15, v15, v87
    v_mul_f32 v13, s58, v15
    v_fma_f32 v84, v84, s58, -v13
    v_fma_f32 v85, v85, s58, -v13
    v_fma_f32 v86, v86, s58, -v13
    v_fma_f32 v87, v87, s58, -v13
    v_exp_f32 v84, v84
    v_exp_f32 v85, v85
    v_exp_f32 v86, v86
    v_exp_f32 v87, v87
    v_mul_f32 v32, v32, v84
    v_mul_f32 v33, v33, v84
    v_mul_f32 v34, v34, v84
    v_mul_f32 v35, v35, v84
    v_mul_f32 v100, v100, v84
    v_mul_f32 v36, v36, v85
    v_mul_f32 v37, v37, v85
    v_mul_f32 v38, v38, v85
    v_mul_f32 v39, v39, v85
    v_mul_f32 v101, v101, v85
    v_fmac_f32 v32, v40, v86
    v_fmac_f32 v33, v41, v86
    v_fmac_f32 v34, v42, v86
    v_fmac_f32 v35, v43, v86
    v_fmac_f32 v100, v102, v86
    v_fmac_f32 v36, v44, v87
    v_fmac_f32 v37, v45, v87
    v_fmac_f32 v38, v46, v87
    v_fmac_f32 v39, v47, v87
    v_fmac_f32 v101, v103, v87
    v_add_f32 v32, v32, v36
    v_add_f32 v33, v33, v37
    v_add_f32 v34, v34, v38
    v_add_f32 v35, v35, v39
    v_add_f32 v100, v100, v101
    v_mov_b32 v112, v32
    v_mov_b32 v113, v33
    v_mov_b32 v116, v34
    v_mov_b32 v117, v35
    v_mov_b32 v120, v15
    v_mov_b32 v121, v100
    s_add_u32 s65, s59, 1900544
    buffer_store_dwordx4 v[112:115], v16, s[44:47], s65 offen
    buffer_store_dwordx4 v[116:119], v16, s[44:47], s65 offen offset:1024
    s_mov_b64 exec, 0x000f000f
    buffer_store_dwordx4 v[120:123], v17, s[44:47], s65 offen offset:2048
    s_mov_b64 exec, -1
    buffer_store_dwordx4 v[112:115], v16, s[44:47], s59 offen sc1
    buffer_store_dwordx4 v[116:119], v16, s[44:47], s59 offen offset:1024 sc1
    s_mov_b64 exec, 0x000f000f
    buffer_store_dwordx4 v[120:123], v17, s[44:47], s59 offen offset:2048 sc1
    s_mov_b64 exec, -1
    v_mov_b32 v7, 0
    v_mov_b32 v6, 1
    s_mov_b64 s[62:63], exec
    s_mov_b64 exec, 1
    ds_add_u32 v7, v6 offset:28
    s_mov_b64 exec, s[62:63]
Lkvdone_30:
    s_branch L_exit
L_kvQ:
    s_sub_u32 s53, s3, 14
    s_sub_u32 s52, s5, 3
    s_mul_i32 s52, s52, 4
    s_add_u32 s52, s52, 24
    s_lshl_b32 s54, s53, 1
    s_add_u32 s52, s52, s54
    s_lshl_b32 s52, s52, 12
    s_lshl_b32 s54, s4, 24
    s_add_u32 s52, s52, s54
    s_add_u32 s52, s52, 15728640
    s_add_u32 s55, s52, 4096
    s_mov_b32 s36, s10
    s_mov_b32 s37, s11
    s_mov_b32 s38, 268435456
    s_mov_b32 s39, 0x20000
    s_mov_b32 s40, s12
    s_mov_b32 s41, s13
    s_mov_b32 s42, 268435456
    s_mov_b32 s43, 0x20000
    v_and_b32 v4, 7, v1
    v_lshlrev_b32 v4, 8, v4
    v_lshrrev_b32 v5, 3, v1
    v_lshl_add_u32 v4, v5, 4, v4
    v_lshlrev_b32 v5, 10, v3
    v_lshl_add_u32 v5, v2, 4, v5
    s_barrier
    v_mov_b32 v7, 0
    s_mov_b32 s61, 0x400000
Lw_31:
    ds_read_b32 v6, v7 offset:24
    s_waitcnt lgkmcnt(0)
    v_readfirstlane_b32 s60, v6
    s_nop 2
    s_cmp_ge_u32 s60, 1
    s_cbranch_scc1 Ld_32
    s_sub_u32 s61, s61, 1
    s_cbranch_scc1 L_abort
    s_sleep 2
    s_branch Lw_31
Ld_32:
    buffer_load_dwordx4 v[32:35], v4, s[36:39], s52 offen offset:0 nt
    buffer_load_dwordx4 v[36:39], v4, s[36:39], s52 offen offset:128 nt
    buffer_load_dwordx4 v[40:43], v4, s[36:39], s52 offen offset:2048 nt
    buffer_load_dwordx4 v[44:47], v4, s[36:39], s52 offen offset:2176 nt
    buffer_load_dwordx4 v[48:51], v4, s[36:39], s55 offen offset:0 nt
    buffer_load_dwordx4 v[52:55], v4, s[36:39], s55 offen offset:128 nt
    buffer_load_dwordx4 v[56:59], v4, s[36:39], s55 offen offset:2048 nt
    buffer_load_dwordx4 v[60:63], v4, s[36:39], s55 offen offset:2176 nt
    v_mov_b32 v7, 0
    v_mov_b32 v6, 1
    s_mov_b64 s[62:63], exec
    s_mov_b64 exec, 1
    ds_add_u32 v7, v6 offset:32
    s_mov_b64 exec, s[62:63]
    v_mov_b32 v7, 0
    s_mov_b32 s61, 0x400000
Lw_33:
    ds_read_b32 v6, v7 offset:32
    s_waitcnt lgkmcnt(0)
    v_readfirstlane_b32 s60, v6
    s_nop 2
    s_cmp_ge_u32 s60, 2
    s_cbranch_scc1 Ld_34
    s_sub_u32 s61, s61, 1
    s_cbranch_scc1 L_abort
    s_sleep 1
    s_branch Lw_33
Ld_34:
    buffer_load_dwordx4 v[64:67], v5, s[40:43], s52 offen offset:0 nt
    buffer_load_dwordx4 v[68:71], v5, s[40:43], s52 offen offset:256 nt
    buffer_load_dwordx4 v[72:75], v5, s[40:43], s52 offen offset:512 nt
    buffer_load_dwordx4 v[76:79], v5, s[40:43], s52 offen offset:768 nt
    buffer_load_dwordx4 v[80:83], v5, s[40:43], s55 offen offset:0 nt
    buffer_load_dwordx4 v[84:87], v5, s[40:43], s55 offen offset:256 nt
    buffer_load_dwordx4 v[88:91], v5, s[40:43], s55 offen offset:512 nt
    buffer_load_dwordx4 v[92:95], v5, s[40:43], s55 offen offset:768 nt
    v_mov_b32 v7, 0
    v_mov_b32 v6, 1
    s_mov_b64 s[62:63], exec
    s_mov_b64 exec, 1
    ds_add_u32 v7, v6 offset:4
    s_mov_b64 exec, s[62:63]
    v_and_b32 v6, 1, v2
    v_lshlrev_b32 v6, 4, v6
    v_mov_b32 v7, 0xffff
    v_lshlrev_b32 v7, v6, v7
    v_bfe_u32 v6, v2, 1, 2
    v_cmp_eq_u32 vcc, 0, v6
    s_nop 1
    v_cndmask_b32 v8, 0, v7, vcc
    v_cmp_eq_u32 vcc, 1, v6
    s_nop 1
    v_cndmask_b32 v9, 0, v7, vcc
    v_cmp_eq_u32 vcc, 2, v6
    s_nop 1
    v_cndmask_b32 v10, 0, v7, vcc
    v_cmp_eq_u32 vcc, 3, v6
    s_nop 1
    v_cndmask_b32 v11, 0, v7, vcc
    v_bfe_u32 v12, v2, 2, 1
    v_lshlrev_b32 v22, 2, v12
    v_lshlrev_b32 v12, 8, v12
    v_lshrrev_b32 v13, 3, v2
    v_lshl_add_u32 v13, v3, 1, v13
    v_lshl_add_u32 v12, v13, 4, v12
    v_add_u32 v12, 512, v12
    v_and_b32 v13, 3, v2
    v_mov_b32 v14, 256
    v_cmp_eq_u32 vcc, 0, v13
    s_nop 1
    v_cndmask_b32 v16, v14, v12, vcc
    v_cmp_eq_u32 vcc, 1, v13
    s_nop 1
    v_cndmask_b32 v17, v14, v12, vcc
    v_cmp_eq_u32 vcc, 2, v13
    s_nop 1
    v_cndmask_b32 v18, v14, v12, vcc
    v_cmp_eq_u32 vcc, 3, v13
    s_nop 1
    v_cndmask_b32 v19, v14, v12, vcc
    v_and_b32 v12, 1, v3
    v_lshlrev_b32 v12, 4, v12
    v_lshrrev_b32 v13, 3, v2
    v_lshl_add_u32 v12, v13, 2, v12
    v_lshrrev_b32 v13, 1, v3
    v_add_u32 v12, v12, v13
    v_lshlrev_b32 v20, 2, v12
    v_add_u32 v21, 8, v20
    s_waitcnt lgkmcnt(0)
    s_add_u32 s6, s6, 0x7f4a7c15
    s_add_u32 s7, s7, 0x9e3779b9
    v_mov_b32 v7, 0
    s_mov_b32 s61, 0x400000
Lw_35:
    ds_read_b32 v6, v7 offset:0
    s_waitcnt lgkmcnt(0)
    v_readfirstlane_b32 s60, v6
    s_nop 2
    s_cmp_ge_u32 s60, 4
    s_cbranch_scc1 Ld_36
    s_sub_u32 s61, s61, 1
    s_cbranch_scc1 L_abort
    s_sleep 2
    s_branch Lw_35
Ld_36:
    s_waitcnt vmcnt(16)
    ds_read_b128 v[96:99], v16 offset:0
    ds_read_b128 v[100:103], v16 offset:128
    ds_read_b128 v[104:107], v17 offset:0
    ds_read_b128 v[108:111], v17 offset:128
    ds_read_b128 v[112:115], v18 offset:0
    ds_read_b128 v[116:119], v18 offset:128
    ds_read_b128 v[120:123], v19 offset:0
    ds_read_b128 v[124:127], v19 offset:128
    s_waitcnt vmcnt(8)
    s_waitcnt lgkmcnt(7)
    v_mfma_f32_16x16x32_bf16 v[24:27], v[32:35], v[96:99], 0
    s_waitcnt lgkmcnt(6)
    v_mfma_f32_16x16x32_bf16 v[24:27], v[36:39], v[100:103], v[24:27]
    s_waitcnt lgkmcnt(5)
    v_mfma_f32_16x16x32_bf16 v[24:27], v[40:43], v[104:107], v[24:27]
    s_waitcnt lgkmcnt(4)
    v_mfma_f32_16x16x32_bf16 v[24:27], v[44:47], v[108:111], v[24:27]
    s_waitcnt lgkmcnt(3)
    v_mfma_f32_16x16x32_bf16 v[24:27], v[48:51], v[112:115], v[24:27]
    s_waitcnt lgkmcnt(2)
    v_mfma_f32_16x16x32_bf16 v[24:27], v[52:55], v[116:119], v[24:27]
    s_waitcnt lgkmcnt(1)
    v_mfma_f32_16x16x32_bf16 v[24:27], v[56:59], v[120:123], v[24:27]
    s_waitcnt lgkmcnt(0)
    v_mfma_f32_16x16x32_bf16 v[24:27], v[60:63], v[124:127], v[24:27]
    s_nop 7
    v_mov_b32 v28, v24
    v_mov_b32 v29, v25
    v_mov_b32 v30, v26
    v_mov_b32 v31, v27
    v_permlane32_swap_b32 v24, v28
    v_permlane32_swap_b32 v25, v29
    v_permlane32_swap_b32 v26, v30
    v_permlane32_swap_b32 v27, v31
    v_add_f32_dpp v24, v28, v24 row_shl:8 row_mask:0xf bank_mask:0xf
    v_add_f32_dpp v25, v29, v25 row_shl:8 row_mask:0xf bank_mask:0xf
    v_add_f32_dpp v26, v30, v26 row_shl:8 row_mask:0xf bank_mask:0xf
    v_add_f32_dpp v27, v31, v27 row_shl:8 row_mask:0xf bank_mask:0xf
    s_mov_b32 s56, 0x3db504f3
    s_mov_b32 s57, 0xffff0000
    s_mov_b32 s58, 0x3fb8aa3b
    v_cvt_pk_bf16_f32 v28, v24, v25
    v_cvt_pk_bf16_f32 v29, v26, v27
    v_lshlrev_b32 v24, 16, v28
    v_and_b32 v25, s57, v28
    v_lshlrev_b32 v26, 16, v29
    v_and_b32 v27, s57, v29
    v_mul_f32 v24, s56, v24
    v_mul_f32 v25, s56, v25
    v_mul_f32 v26, s56, v26
    v_mul_f32 v27, s56, v27
    v_cvt_pk_bf16_f32 v28, v24, v25
    v_cvt_pk_bf16_f32 v29, v26, v27
    v_lshlrev_b32 v24, 16, v28
    v_and_b32 v25, s57, v28
    v_lshlrev_b32 v26, 16, v29
    v_and_b32 v27, s57, v29
    v_max3_f32 v12, v24, v25, v26
    v_max_f32 v12, v12, v27
    s_nop 1
    v_max_f32_dpp v12, v12, v12 quad_perm:[1,0,3,2] row_mask:0xf bank_mask:0xf
    s_nop 1
    v_max_f32_dpp v12, v12, v12 quad_perm:[2,3,0,1] row_mask:0xf bank_mask:0xf
    v_mov_b32 v13, v12
    s_nop 1
    v_permlane16_swap_b32 v12, v13
    v_max_f32 v12, v12, v13
    s_lshl_b32 s59, s53, 3
    v_add_u32 v23, s59, v22
    s_mov_b64 s[62:63], exec
    s_mov_b64 exec, 0x11
    ds_write_b32 v23, v12 offset:1024
    s_mov_b64 exec, s[62:63]
    v_mov_b32 v15, v12
    v_mul_f32 v13, s58, v15
    v_fma_f32 v24, v24, s58, -v13
    v_fma_f32 v25, v25, s58, -v13
    v_fma_f32 v26, v26, s58, -v13
    v_fma_f32 v27, v27, s58, -v13
    v_exp_f32 v24, v24
    v_exp_f32 v25, v25
    v_exp_f32 v26, v26
    v_exp_f32 v27, v27
    v_add_f32 v12, v24, v25
    v_add_f32 v13, v26, v27
    v_cvt_pk_bf16_f32 v24, v24, v24
    v_cvt_pk_bf16_f32 v25, v25, v25
    v_cvt_pk_bf16_f32 v26, v26, v26
    v_cvt_pk_bf16_f32 v27, v27, v27
    v_add_f32 v12, v12, v13
    ds_bpermute_b32 v104, v20, v24
    ds_bpermute_b32 v105, v20, v25
    ds_bpermute_b32 v106, v20, v26
    ds_bpermute_b32 v107, v20, v27
    ds_bpermute_b32 v108, v21, v24
    ds_bpermute_b32 v109, v21, v25
    ds_bpermute_b32 v110, v21, v26
    ds_bpermute_b32 v111, v21, v27
    v_add_f32_dpp v12, v12, v12 quad_perm:[1,0,3,2] row_mask:0xf bank_mask:0xf
    s_nop 1
    v_add_f32_dpp v12, v12, v12 quad_perm:[2,3,0,1] row_mask:0xf bank_mask:0xf
    v_mov_b32 v13, v12
    s_nop 1
    v_permlane16_swap_b32 v12, v13
    v_add_f32 v12, v12, v13
    s_mov_b64 s[62:63], exec
    s_mov_b64 exec, 0x11
    ds_write_b32 v23, v12 offset:1152
    s_mov_b64 exec, s[62:63]
    s_waitcnt lgkmcnt(1)
    v_and_b32 v32, v104, v8
    v_and_b32 v33, v104, v9
    v_and_b32 v34, v104, v10
    v_and_b32 v35, v104, v11
    v_and_b32 v36, v105, v8
    v_and_b32 v37, v105, v9
    v_and_b32 v38, v105, v10
    v_and_b32 v39, v105, v11
    v_and_b32 v40, v106, v8
    v_and_b32 v41, v106, v9
    v_and_b32 v42, v106, v10
    v_and_b32 v43, v106, v11
    v_and_b32 v44, v107, v8
    v_and_b32 v45, v107, v9
    v_and_b32 v46, v107, v10
    v_and_b32 v47, v107, v11
    v_and_b32 v48, v108, v8
    v_and_b32 v49, v108, v9
    v_and_b32 v50, v108, v10
    v_and_b32 v51, v108, v11
    v_and_b32 v52, v109, v8
    v_and_b32 v53, v109, v9
    v_and_b32 v54, v109, v10
    v_and_b32 v55, v109, v11
    v_and_b32 v56, v110, v8
    v_and_b32 v57, v110, v9
    v_and_b32 v58, v110, v10
    v_and_b32 v59, v110, v11
    v_and_b32 v60, v111, v8
    v_and_b32 v61, v111, v9
    v_and_b32 v62, v111, v10
    v_and_b32 v63, v111, v11
    v_mov_b32 v114, s6
    v_mov_b32 v115, s7
    v_mov_b32 v118, s6
    v_mov_b32 v119, s7
    v_mov_b32 v122, s6
    v_mov_b32 v123, s7
    s_waitcnt vmcnt(0)
    v_mfma_f32_16x16x32_bf16 v[96:99], v[64:67], v[32:35], 0
    v_mfma_f32_16x16x32_bf16 v[96:99], v[68:71], v[36:39], v[96:99]
    v_mfma_f32_16x16x32_bf16 v[96:99], v[72:75], v[40:43], v[96:99]
    v_mfma_f32_16x16x32_bf16 v[96:99], v[76:79], v[44:47], v[96:99]
    v_mfma_f32_16x16x32_bf16 v[96:99], v[80:83], v[48:51], v[96:99]
    v_mfma_f32_16x16x32_bf16 v[96:99], v[84:87], v[52:55], v[96:99]
    v_mfma_f32_16x16x32_bf16 v[96:99], v[88:91], v[56:59], v[96:99]
    v_mfma_f32_16x16x32_bf16 v[96:99], v[92:95], v[60:63], v[96:99]
    s_lshl_b32 s59, s53, 10
    v_lshlrev_b32 v16, 4, v1
    v_add_u32 v17, s59, v16
    s_nop 4
    ds_write_b128 v17, v[96:99] offset:23040
    v_mov_b32 v7, 0
    v_mov_b32 v6, 1
    s_mov_b64 s[62:63], exec
    s_mov_b64 exec, 1
    ds_add_rtn_u32 v6, v7, v6 offset:12
    s_waitcnt lgkmcnt(0)
    v_readfirstlane_b32 s60, v6
    s_mov_b64 exec, s[62:63]
    s_nop 1
    s_cmp_lg_u32 s60, 1
    s_cbranch_scc1 Lkvdone_37
    v_lshlrev_b32 v18, 3, v1
    ds_read_b64 v[32:33], v18 offset:23040
    ds_read_b64 v[34:35], v18 offset:23552
    ds_read_b64 v[36:37], v18 offset:24064
    ds_read_b64 v[38:39], v18 offset:24576
    v_bfe_u32 v19, v1, 4, 1
    v_lshlrev_b32 v21, 2, v19
    v_lshlrev_b32 v17, 6, v19
    v_and_b32 v19, 3, v1
    v_lshl_add_u32 v17, v19, 4, v17
    ds_read_b32 v84, v21 offset:1024
    ds_read_b32 v85, v21 offset:1032
    ds_read_b32 v100, v21 offset:1152
    ds_read_b32 v101, v21 offset:1160
    s_lshl_b32 s59, s4, 4
    s_add_u32 s59, s59, s5
    s_mul_i32 s59, s59, 2560
    s_add_u32 s59, s59, 262144
    s_waitcnt lgkmcnt(0)
    v_mov_b32 v15, v84
    v_max_f32 v15, v15, v85
    v_mul_f32 v13, s58, v15
    v_fma_f32 v84, v84, s58, -v13
    v_fma_f32 v85, v85, s58, -v13
    v_exp_f32 v84, v84
    v_exp_f32 v85, v85
    v_mul_f32 v32, v32, v84
    v_mul_f32 v33, v33, v84
    v_mul_f32 v34, v34, v84
    v_mul_f32 v35, v35, v84
    v_mul_f32 v100, v100, v84
    v_mul_f32 v36, v36, v85
    v_mul_f32 v37, v37, v85
    v_mul_f32 v38, v38, v85
    v_mul_f32 v39, v39, v85
    v_mul_f32 v101, v101, v85
    v_add_f32 v32, v32, v36
    v_add_f32 v33, v33, v37
    v_add_f32 v34, v34, v38
    v_add_f32 v35, v35, v39
    v_add_f32 v100, v100, v101
    v_mov_b32 v112, v32
    v_mov_b32 v113, v33
    v_mov_b32 v116, v34
    v_mov_b32 v117, v35
    v_mov_b32 v120, v15
    v_mov_b32 v121, v100
    s_add_u32 s65, s59, 1900544
    buffer_store_dwordx4 v[112:115], v16, s[44:47], s65 offen
    buffer_store_dwordx4 v[116:119], v16, s[44:47], s65 offen offset:1024
    s_mov_b64 exec, 0x000f000f
    buffer_store_dwordx4 v[120:123], v17, s[44:47], s65 offen offset:2048
    s_mov_b64 exec, -1
    buffer_store_dwordx4 v[112:115], v16, s[44:47], s59 offen sc1
    buffer_store_dwordx4 v[116:119], v16, s[44:47], s59 offen offset:1024 sc1
    s_mov_b64 exec, 0x000f000f
    buffer_store_dwordx4 v[120:123], v17, s[44:47], s59 offen offset:2048 sc1
    s_mov_b64 exec, -1
    v_mov_b32 v7, 0
    v_mov_b32 v6, 1
    s_mov_b64 s[62:63], exec
    s_mov_b64 exec, 1
    ds_add_u32 v7, v6 offset:28
    s_mov_b64 exec, s[62:63]
Lkvdone_37:
    s_branch L_exit
L_woQ:
    s_barrier
    v_mov_b32 v7, 0
    s_mov_b32 s61, 0x400000
Lw_38:
    ds_read_b32 v6, v7 offset:4
    s_waitcnt lgkmcnt(0)
    v_readfirstlane_b32 s60, v6
    s_nop 2
    s_cmp_ge_u32 s60, 2
    s_cbranch_scc1 Ld_39
    s_sub_u32 s61, s61, 1
    s_cbranch_scc1 L_abort
    s_sleep 2
    s_branch Lw_38
Ld_39:
    s_branch L_wo_common
L_woM:
    s_barrier
    v_mov_b32 v7, 0
    s_mov_b32 s61, 0x400000
Lw_40:
    ds_read_b32 v6, v7 offset:4
    s_waitcnt lgkmcnt(0)
    v_readfirstlane_b32 s60, v6
    s_nop 2
    s_cmp_ge_u32 s60, 4
    s_cbranch_scc1 Ld_41
    s_sub_u32 s61, s61, 1
    s_cbranch_scc1 L_abort
    s_sleep 2
    s_branch Lw_40
Ld_41:
    s_branch L_wo_common
L_wo_common:
    s_mov_b32 s36, s16
    s_mov_b32 s37, s17
    s_mov_b32 s38, 4718592
    s_mov_b32 s39, 0x20000
    s_sub_u32 s53, s3, 7
    s_mov_b32 s54, s5
    s_mul_i32 s55, s54, 9
    s_lshl_b32 s56, s4, 8
    s_cmp_eq_u32 s53, 2
    s_cbranch_scc1 L_wo_half
    s_lshl_b32 s65, s53, 9
    v_mul_u32_u24 v4, 9216, v3
    v_lshl_add_u32 v4, v2, 4, v4
    s_add_u32 s57, s55, 0
    s_bfe_u32 s58, s57, 0x10003
    s_lshl_b32 s58, s58, 7
    s_lshr_b32 s60, s57, 4
    s_lshl_b32 s60, s60, 5
    s_add_u32 s58, s58, s60
    s_and_b32 s60, s57, 7
    s_add_u32 s58, s58, s60
    s_add_u32 s58, s58, s56
    s_mul_i32 s66, s58, 1152
    s_add_u32 s66, s66, s65
    buffer_load_dwordx4 v[32:35], v4, s[36:39], s66 offen nt
    buffer_load_dwordx4 v[36:39], v4, s[36:39], s66 offen offset:256 nt
    s_add_u32 s57, s55, 1
    s_bfe_u32 s58, s57, 0x10003
    s_lshl_b32 s58, s58, 7
    s_lshr_b32 s60, s57, 4
    s_lshl_b32 s60, s60, 5
    s_add_u32 s58, s58, s60
    s_and_b32 s60, s57, 7
    s_add_u32 s58, s58, s60
    s_add_u32 s58, s58, s56
    s_mul_i32 s66, s58, 1152
    s_add_u32 s66, s66, s65
    buffer_load_dwordx4 v[40:43], v4, s[36:39], s66 offen nt
    buffer_load_dwordx4 v[44:47], v4, s[36:39], s66 offen offset:256 nt
    s_add_u32 s57, s55, 2
    s_bfe_u32 s58, s57, 0x10003
    s_lshl_b32 s58, s58, 7
    s_lshr_b32 s60, s57, 4
    s_lshl_b32 s60, s60, 5
    s_add_u32 s58, s58, s60
    s_and_b32 s60, s57, 7
    s_add_u32 s58, s58, s60
    s_add_u32 s58, s58, s56
    s_mul_i32 s66, s58, 1152
    s_add_u32 s66, s66, s65
    buffer_load_dwordx4 v[48:51], v4, s[36:39], s66 offen nt
    buffer_load_dwordx4 v[52:55], v4, s[36:39], s66 offen offset:256 nt
    s_add_u32 s57, s55, 3
    s_bfe_u32 s58, s57, 0x10003
    s_lshl_b32 s58, s58, 7
    s_lshr_b32 s60, s57, 4
    s_lshl_b32 s60, s60, 5
    s_add_u32 s58, s58, s60
    s_and_b32 s60, s57, 7
    s_add_u32 s58, s58, s60
    s_add_u32 s58, s58, s56
    s_mul_i32 s66, s58, 1152
    s_add_u32 s66, s66, s65
    buffer_load_dwordx4 v[56:59], v4, s[36:39], s66 offen nt
    buffer_load_dwordx4 v[60:63], v4, s[36:39], s66 offen offset:256 nt
    s_add_u32 s57, s55, 4
    s_bfe_u32 s58, s57, 0x10003
    s_lshl_b32 s58, s58, 7
    s_lshr_b32 s60, s57, 4
    s_lshl_b32 s60, s60, 5
    s_add_u32 s58, s58, s60
    s_and_b32 s60, s57, 7
    s_add_u32 s58, s58, s60
    s_add_u32 s58, s58, s56
    s_mul_i32 s66, s58, 1152
    s_add_u32 s66, s66, s65
    buffer_load_dwordx4 v[64:67], v4, s[36:39], s66 offen nt
    buffer_load_dwordx4 v[68:71], v4, s[36:39], s66 offen offset:256 nt
    s_add_u32 s57, s55, 5
    s_bfe_u32 s58, s57, 0x10003
    s_lshl_b32 s58, s58, 7
    s_lshr_b32 s60, s57, 4
    s_lshl_b32 s60, s60, 5
    s_add_u32 s58, s58, s60
    s_and_b32 s60, s57, 7
    s_add_u32 s58, s58, s60
    s_add_u32 s58, s58, s56
    s_mul_i32 s66, s58, 1152
    s_add_u32 s66, s66, s65
    buffer_load_dwordx4 v[72:75], v4, s[36:39], s66 offen nt
    buffer_load_dwordx4 v[76:79], v4, s[36:39], s66 offen offset:256 nt
    s_add_u32 s57, s55, 6
    s_bfe_u32 s58, s57, 0x10003
    s_lshl_b32 s58, s58, 7
    s_lshr_b32 s60, s57, 4
    s_lshl_b32 s60, s60, 5
    s_add_u32 s58, s58, s60
    s_and_b32 s60, s57, 7
    s_add_u32 s58, s58, s60
    s_add_u32 s58, s58, s56
    s_mul_i32 s66, s58, 1152
    s_add_u32 s66, s66, s65
    buffer_load_dwordx4 v[80:83], v4, s[36:39], s66 offen nt
    buffer_load_dwordx4 v[84:87], v4, s[36:39], s66 offen offset:256 nt
    s_add_u32 s57, s55, 7
    s_bfe_u32 s58, s57, 0x10003
    s_lshl_b32 s58, s58, 7
    s_lshr_b32 s60, s57, 4
    s_lshl_b32 s60, s60, 5
    s_add_u32 s58, s58, s60
    s_and_b32 s60, s57, 7
    s_add_u32 s58, s58, s60
    s_add_u32 s58, s58, s56
    s_mul_i32 s66, s58, 1152
    s_add_u32 s66, s66, s65
    buffer_load_dwordx4 v[88:91], v4, s[36:39], s66 offen nt
    buffer_load_dwordx4 v[92:95], v4, s[36:39], s66 offen offset:256 nt
    s_add_u32 s57, s55, 8
    s_bfe_u32 s58, s57, 0x10003
    s_lshl_b32 s58, s58, 7
    s_lshr_b32 s60, s57, 4
    s_lshl_b32 s60, s60, 5
    s_add_u32 s58, s58, s60
    s_and_b32 s60, s57, 7
    s_add_u32 s58, s58, s60
    s_add_u32 s58, s58, s56
    s_mul_i32 s66, s58, 1152
    s_add_u32 s66, s66, s65
    buffer_load_dwordx4 v[96:99], v4, s[36:39], s66 offen nt
    buffer_load_dwordx4 v[100:103], v4, s[36:39], s66 offen offset:256 nt
    s_cmp_lt_u32 s54, 6
    s_cbranch_scc1 L_wo_l9
    s_add_u32 s57, s55, 9
    s_bfe_u32 s58, s57, 0x10003
    s_lshl_b32 s58, s58, 7
    s_lshr_b32 s60, s57, 4
    s_lshl_b32 s60, s60, 5
    s_add_u32 s58, s58, s60
    s_and_b32 s60, s57, 7
    s_add_u32 s58, s58, s60
    s_add_u32 s58, s58, s56
    s_mul_i32 s66, s58, 1152
    s_add_u32 s66, s66, s65
    buffer_load_dwordx4 v[104:107], v4, s[36:39], s66 offen nt
    buffer_load_dwordx4 v[108:111], v4, s[36:39], s66 offen offset:256 nt
L_wo_l9:
    v_lshlrev_b32 v5, 2, v3
    v_mov_b32 v7, 0
    v_mov_b32 v6, 1
    s_mov_b64 s[62:63], exec
    s_mov_b64 exec, 1
    ds_add_u32 v7, v6 offset:48
    s_mov_b64 exec, s[62:63]
    v_and_b32 v6, 1, v2
    v_lshlrev_b32 v6, 4, v6
    v_mov_b32 v7, 0xffff
    v_lshlrev_b32 v7, v6, v7
    v_bfe_u32 v6, v2, 1, 2
    v_cmp_eq_u32 vcc, 0, v6
    s_nop 1
    v_cndmask_b32 v8, 0, v7, vcc
    v_cmp_eq_u32 vcc, 1, v6
    s_nop 1
    v_cndmask_b32 v9, 0, v7, vcc
    v_cmp_eq_u32 vcc, 2, v6
    s_nop 1
    v_cndmask_b32 v10, 0, v7, vcc
    v_cmp_eq_u32 vcc, 3, v6
    s_nop 1
    v_cndmask_b32 v11, 0, v7, vcc
    v_and_b32 v12, 7, v2
    v_lshl_add_u32 v12, v3, 3, v12
    v_lshlrev_b32 v12, 5, v12
    v_lshrrev_b32 v6, 3, v2
    v_lshl_add_u32 v12, v6, 4, v12
    s_waitcnt lgkmcnt(0)
    s_add_u32 s6, s6, 0x7f4a7c15
    s_add_u32 s7, s7, 0x9e3779b9
    s_mul_i32 s59, s4, 7
    s_add_u32 s59, s59, s54
    s_mul_i32 s59, s59, 4608
    s_add_u32 s59, s59, 917504
    v_mov_b32 v18, s6
    v_mov_b32 v19, s7
    v_mov_b32 v22, s6
    v_mov_b32 v23, s7
    s_barrier
    ds_read_b32 v112, v5 offset:4352
    ds_read_b32 v113, v5 offset:4368
    ds_read_b32 v114, v5 offset:4384
    ds_read_b32 v115, v5 offset:4400
    ds_read_b32 v116, v5 offset:4416
    ds_read_b32 v117, v5 offset:4432
    ds_read_b32 v118, v5 offset:4448
    ds_read_b32 v119, v5 offset:4464
    ds_read_b32 v13, v5 offset:4480
    ds_read_b32 v14, v5 offset:4496
    s_waitcnt vmcnt(0) lgkmcnt(0)
    s_cmp_lt_u32 s54, 6
    s_cbranch_scc1 L_wo_m9
    v_and_b32 v4, v112, v8
    v_and_b32 v5, v112, v9
    v_and_b32 v6, v112, v10
    v_and_b32 v7, v112, v11
    s_nop 1
    v_mfma_f32_16x16x32_bf16 v[24:27], v[32:35], v[4:7], 0
    v_mfma_f32_16x16x32_bf16 v[28:31], v[36:39], v[4:7], 0
    v_and_b32 v32, v113, v8
    v_and_b32 v33, v113, v9
    v_and_b32 v34, v113, v10
    v_and_b32 v35, v113, v11
    s_nop 1
    v_mfma_f32_16x16x32_bf16 v[24:27], v[40:43], v[32:35], v[24:27]
    v_mfma_f32_16x16x32_bf16 v[28:31], v[44:47], v[32:35], v[28:31]
    v_and_b32 v40, v114, v8
    v_and_b32 v41, v114, v9
    v_and_b32 v42, v114, v10
    v_and_b32 v43, v114, v11
    s_nop 1
    v_mfma_f32_16x16x32_bf16 v[24:27], v[48:51], v[40:43], v[24:27]
    v_mfma_f32_16x16x32_bf16 v[28:31], v[52:55], v[40:43], v[28:31]
    v_and_b32 v48, v115, v8
    v_and_b32 v49, v115, v9
    v_and_b32 v50, v115, v10
    v_and_b32 v51, v115, v11
    s_nop 1
    v_mfma_f32_16x16x32_bf16 v[24:27], v[56:59], v[48:51], v[24:27]
    v_mfma_f32_16x16x32_bf16 v[28:31], v[60:63], v[48:51], v[28:31]
    v_and_b32 v56, v116, v8
    v_and_b32 v57, v116, v9
    v_and_b32 v58, v116, v10
    v_and_b32 v59, v116, v11
    s_nop 1
    v_mfma_f32_16x16x32_bf16 v[24:27], v[64:67], v[56:59], v[24:27]
    v_mfma_f32_16x16x32_bf16 v[28:31], v[68:71], v[56:59], v[28:31]
    v_and_b32 v64, v117, v8
    v_and_b32 v65, v117, v9
    v_and_b32 v66, v117, v10
    v_and_b32 v67, v117, v11
    s_nop 1
    v_mfma_f32_16x16x32_bf16 v[24:27], v[72:75], v[64:67], v[24:27]
    v_mfma_f32_16x16x32_bf16 v[28:31], v[76:79], v[64:67], v[28:31]
    v_and_b32 v72, v118, v8
    v_and_b32 v73, v118, v9
    v_and_b32 v74, v118, v10
    v_and_b32 v75, v118, v11
    s_nop 1
    v_mfma_f32_16x16x32_bf16 v[24:27], v[80:83], v[72:75], v[24:27]
    v_mfma_f32_16x16x32_bf16 v[28:31], v[84:87], v[72:75], v[28:31]
    v_and_b32 v80, v119, v8
    v_and_b32 v81, v119, v9
    v_and_b32 v82, v119, v10
    v_and_b32 v83, v119, v11
    s_nop 1
    v_mfma_f32_16x16x32_bf16 v[24:27], v[88:91], v[80:83], v[24:27]
    v_mfma_f32_16x16x32_bf16 v[28:31], v[92:95], v[80:83], v[28:31]
    v_and_b32 v88, v13, v8
    v_and_b32 v89, v13, v9
    v_and_b32 v90, v13, v10
    v_and_b32 v91, v13, v11
    s_nop 1
    v_mfma_f32_16x16x32_bf16 v[24:27], v[96:99], v[88:91], v[24:27]
    v_mfma_f32_16x16x32_bf16 v[28:31], v[100:103], v[88:91], v[28:31]
    v_and_b32 v96, v14, v8
    v_and_b32 v97, v14, v9
    v_and_b32 v98, v14, v10
    v_and_b32 v99, v14, v11
    s_nop 1
    v_mfma_f32_16x16x32_bf16 v[24:27], v[104:107], v[96:99], v[24:27]
    v_mfma_f32_16x16x32_bf16 v[28:31], v[108:111], v[96:99], v[28:31]
    s_branch L_wo_st
L_wo_m9:
    v_and_b32 v4, v112, v8
    v_and_b32 v5, v112, v9
    v_and_b32 v6, v112, v10
    v_and_b32 v7, v112, v11
    s_nop 1
    v_mfma_f32_16x16x32_bf16 v[24:27], v[32:35], v[4:7], 0
    v_mfma_f32_16x16x32_bf16 v[28:31], v[36:39], v[4:7], 0
    v_and_b32 v32, v113, v8
    v_and_b32 v33, v113, v9
    v_and_b32 v34, v113, v10
    v_and_b32 v35, v113, v11
    s_nop 1
    v_mfma_f32_16x16x32_bf16 v[24:27], v[40:43], v[32:35], v[24:27]
    v_mfma_f32_16x16x32_bf16 v[28:31], v[44:47], v[32:35], v[28:31]
    v_and_b32 v40, v114, v8
    v_and_b32 v41, v114, v9
    v_and_b32 v42, v114, v10
    v_and_b32 v43, v114, v11
    s_nop 1
    v_mfma_f32_16x16x32_bf16 v[24:27], v[48:51], v[40:43], v[24:27]
    v_mfma_f32_16x16x32_bf16 v[28:31], v[52:55], v[40:43], v[28:31]
    v_and_b32 v48, v115, v8
    v_and_b32 v49, v115, v9
    v_and_b32 v50, v115, v10
    v_and_b32 v51, v115, v11
    s_nop 1
    v_mfma_f32_16x16x32_bf16 v[24:27], v[56:59], v[48:51], v[24:27]
    v_mfma_f32_16x16x32_bf16 v[28:31], v[60:63], v[48:51], v[28:31]
    v_and_b32 v56, v116, v8
    v_and_b32 v57, v116, v9
    v_and_b32 v58, v116, v10
    v_and_b32 v59, v116, v11
    s_nop 1
    v_mfma_f32_16x16x32_bf16 v[24:27], v[64:67], v[56:59], v[24:27]
    v_mfma_f32_16x16x32_bf16 v[28:31], v[68:71], v[56:59], v[28:31]
    v_and_b32 v64, v117, v8
    v_and_b32 v65, v117, v9
    v_and_b32 v66, v117, v10
    v_and_b32 v67, v117, v11
    s_nop 1
    v_mfma_f32_16x16x32_bf16 v[24:27], v[72:75], v[64:67], v[24:27]
    v_mfma_f32_16x16x32_bf16 v[28:31], v[76:79], v[64:67], v[28:31]
    v_and_b32 v72, v118, v8
    v_and_b32 v73, v118, v9
    v_and_b32 v74, v118, v10
    v_and_b32 v75, v118, v11
    s_nop 1
    v_mfma_f32_16x16x32_bf16 v[24:27], v[80:83], v[72:75], v[24:27]
    v_mfma_f32_16x16x32_bf16 v[28:31], v[84:87], v[72:75], v[28:31]
    v_and_b32 v80, v119, v8
    v_and_b32 v81, v119, v9
    v_and_b32 v82, v119, v10
    v_and_b32 v83, v119, v11
    s_nop 1
    v_mfma_f32_16x16x32_bf16 v[24:27], v[88:91], v[80:83], v[24:27]
    v_mfma_f32_16x16x32_bf16 v[28:31], v[92:95], v[80:83], v[28:31]
    v_and_b32 v88, v13, v8
    v_and_b32 v89, v13, v9
    v_and_b32 v90, v13, v10
    v_and_b32 v91, v13, v11
    s_nop 1
    v_mfma_f32_16x16x32_bf16 v[24:27], v[96:99], v[88:91], v[24:27]
    v_mfma_f32_16x16x32_bf16 v[28:31], v[100:103], v[88:91], v[28:31]
L_wo_st:
    s_nop 6
    v_mov_b32 v16, v24
    v_mov_b32 v17, v25
    s_nop 0
    v_mov_b32_dpp v16, v26 row_shr:8 row_mask:0xf bank_mask:0xc
    v_mov_b32_dpp v17, v27 row_shr:8 row_mask:0xf bank_mask:0xc
    v_mov_b32 v20, v28
    v_mov_b32 v21, v29
    s_nop 0
    v_mov_b32_dpp v20, v30 row_shr:8 row_mask:0xf bank_mask:0xc
    v_mov_b32_dpp v21, v31 row_shr:8 row_mask:0xf bank_mask:0xc
    s_lshl_b32 s60, s53, 11
    s_add_u32 s59, s59, s60
    buffer_store_dwordx4 v[16:19], v12, s[44:47], s59 offen sc1
    buffer_store_dwordx4 v[20:23], v12, s[44:47], s59 offen offset:1024 sc1
    s_branch L_exit
L_wo_half:
    v_mul_u32_u24 v4, 9216, v3
    v_and_b32 v6, 7, v2
    v_lshl_add_u32 v4, v6, 4, v4
    v_add_u32 v4, 1024, v4
    v_cmp_lt_u32 s[68:69], 7, v2
    s_add_u32 s57, s55, 0
    s_bfe_u32 s58, s57, 0x10003
    s_lshl_b32 s58, s58, 7
    s_lshr_b32 s60, s57, 4
    s_lshl_b32 s60, s60, 5
    s_add_u32 s58, s58, s60
    s_and_b32 s60, s57, 7
    s_add_u32 s58, s58, s60
    s_add_u32 s58, s58, s56
    s_mul_i32 s66, s58, 1152
    s_add_u32 s57, s55, 1
    s_bfe_u32 s58, s57, 0x10003
    s_lshl_b32 s58, s58, 7
    s_lshr_b32 s60, s57, 4
    s_lshl_b32 s60, s60, 5
    s_add_u32 s58, s58, s60
    s_and_b32 s60, s57, 7
    s_add_u32 s58, s58, s60
    s_add_u32 s58, s58, s56
    s_mul_i32 s67, s58, 1152
    v_mov_b32 v6, s66
    v_mov_b32 v7, s67
    v_cndmask_b32 v6, v6, v7, s[68:69]
    v_add_u32 v6, v6, v4
    buffer_load_dwordx4 v[32:35], v6, s[36:39], 0 offen nt
    s_add_u32 s57, s55, 2
    s_bfe_u32 s58, s57, 0x10003
    s_lshl_b32 s58, s58, 7
    s_lshr_b32 s60, s57, 4
    s_lshl_b32 s60, s60, 5
    s_add_u32 s58, s58, s60
    s_and_b32 s60, s57, 7
    s_add_u32 s58, s58, s60
    s_add_u32 s58, s58, s56
    s_mul_i32 s66, s58, 1152
    s_add_u32 s57, s55, 3
    s_bfe_u32 s58, s57, 0x10003
    s_lshl_b32 s58, s58, 7
    s_lshr_b32 s60, s57, 4
    s_lshl_b32 s60, s60, 5
    s_add_u32 s58, s58, s60
    s_and_b32 s60, s57, 7
    s_add_u32 s58, s58, s60
    s_add_u32 s58, s58, s56
    s_mul_i32 s67, s58, 1152
    v_mov_b32 v6, s66
    v_mov_b32 v7, s67
    v_cndmask_b32 v6, v6, v7, s[68:69]
    v_add_u32 v6, v6, v4
    buffer_load_dwordx4 v[36:39], v6, s[36:39], 0 offen nt
    s_add_u32 s57, s55, 4
    s_bfe_u32 s58, s57, 0x10003
    s_lshl_b32 s58, s58, 7
    s_lshr_b32 s60, s57, 4
    s_lshl_b32 s60, s60, 5
    s_add_u32 s58, s58, s60
    s_and_b32 s60, s57, 7
    s_add_u32 s58, s58, s60
    s_add_u32 s58, s58, s56
    s_mul_i32 s66, s58, 1152
    s_add_u32 s57, s55, 5
    s_bfe_u32 s58, s57, 0x10003
    s_lshl_b32 s58, s58, 7
    s_lshr_b32 s60, s57, 4
    s_lshl_b32 s60, s60, 5
    s_add_u32 s58, s58, s60
    s_and_b32 s60, s57, 7
    s_add_u32 s58, s58, s60
    s_add_u32 s58, s58, s56
    s_mul_i32 s67, s58, 1152
    v_mov_b32 v6, s66
    v_mov_b32 v7, s67
    v_cndmask_b32 v6, v6, v7, s[68:69]
    v_add_u32 v6, v6, v4
    buffer_load_dwordx4 v[40:43], v6, s[36:39], 0 offen nt
    s_add_u32 s57, s55, 6
    s_bfe_u32 s58, s57, 0x10003
    s_lshl_b32 s58, s58, 7
    s_lshr_b32 s60, s57, 4
    s_lshl_b32 s60, s60, 5
    s_add_u32 s58, s58, s60
    s_and_b32 s60, s57, 7
    s_add_u32 s58, s58, s60
    s_add_u32 s58, s58, s56
    s_mul_i32 s66, s58, 1152
    s_add_u32 s57, s55, 7
    s_bfe_u32 s58, s57, 0x10003
    s_lshl_b32 s58, s58, 7
    s_lshr_b32 s60, s57, 4
    s_lshl_b32 s60, s60, 5
    s_add_u32 s58, s58, s60
    s_and_b32 s60, s57, 7
    s_add_u32 s58, s58, s60
    s_add_u32 s58, s58, s56
    s_mul_i32 s67, s58, 1152
    v_mov_b32 v6, s66
    v_mov_b32 v7, s67
    v_cndmask_b32 v6, v6, v7, s[68:69]
    v_add_u32 v6, v6, v4
    buffer_load_dwordx4 v[44:47], v6, s[36:39], 0 offen nt
    s_add_u32 s57, s55, 8
    s_bfe_u32 s58, s57, 0x10003
    s_lshl_b32 s58, s58, 7
    s_lshr_b32 s60, s57, 4
    s_lshl_b32 s60, s60, 5
    s_add_u32 s58, s58, s60
    s_and_b32 s60, s57, 7
    s_add_u32 s58, s58, s60
    s_add_u32 s58, s58, s56
    s_mul_i32 s66, s58, 1152
    s_add_u32 s57, s55, 9
    s_bfe_u32 s58, s57, 0x10003
    s_lshl_b32 s58, s58, 7
    s_lshr_b32 s60, s57, 4
    s_lshl_b32 s60, s60, 5
    s_add_u32 s58, s58, s60
    s_and_b32 s60, s57, 7
    s_add_u32 s58, s58, s60
    s_add_u32 s58, s58, s56
    s_mul_i32 s67, s58, 1152
    s_cmp_lt_u32 s54, 6
    s_cselect_b32 s67, 0x40000000, s67
    v_mov_b32 v6, s66
    v_mov_b32 v7, s67
    v_cndmask_b32 v6, v6, v7, s[68:69]
    v_add_u32 v6, v6, v4
    buffer_load_dwordx4 v[48:51], v6, s[36:39], 0 offen nt
    v_lshrrev_b32 v5, 3, v2
    v_lshl_add_u32 v5, v5, 2, v3
    v_lshlrev_b32 v5, 2, v5
    v_mov_b32 v7, 0
    v_mov_b32 v6, 1
    s_mov_b64 s[62:63], exec
    s_mov_b64 exec, 1
    ds_add_u32 v7, v6 offset:48
    s_mov_b64 exec, s[62:63]
    v_and_b32 v6, 1, v2
    v_lshlrev_b32 v6, 4, v6
    v_mov_b32 v7, 0xffff
    v_lshlrev_b32 v7, v6, v7
    v_bfe_u32 v6, v2, 1, 2
    v_cmp_eq_u32 vcc, 0, v6
    s_nop 1
    v_cndmask_b32 v8, 0, v7, vcc
    v_cmp_eq_u32 vcc, 1, v6
    s_nop 1
    v_cndmask_b32 v9, 0, v7, vcc
    v_cmp_eq_u32 vcc, 2, v6
    s_nop 1
    v_cndmask_b32 v10, 0, v7, vcc
    v_cmp_eq_u32 vcc, 3, v6
    s_nop 1
    v_cndmask_b32 v11, 0, v7, vcc
    v_and_b32 v12, 7, v2
    v_lshl_add_u32 v12, v3, 3, v12
    v_lshlrev_b32 v12, 5, v12
    v_lshrrev_b32 v6, 3, v2
    v_lshl_add_u32 v12, v6, 4, v12
    s_waitcnt lgkmcnt(0)
    s_add_u32 s6, s6, 0x7f4a7c15
    s_add_u32 s7, s7, 0x9e3779b9
    s_mul_i32 s59, s4, 7
    s_add_u32 s59, s59, s54
    s_mul_i32 s59, s59, 4608
    s_add_u32 s59, s59, 917504
    v_mov_b32 v98, s6
    v_mov_b32 v99, s7
    s_barrier
    ds_read_b32 v112, v5 offset:4352
    ds_read_b32 v113, v5 offset:4384
    ds_read_b32 v114, v5 offset:4416
    ds_read_b32 v115, v5 offset:4448
    ds_read_b32 v116, v5 offset:4480
    s_waitcnt vmcnt(0) lgkmcnt(0)
    v_and_b32 v76, v112, v8
    v_and_b32 v77, v112, v9
    v_and_b32 v78, v112, v10
    v_and_b32 v79, v112, v11
    v_and_b32 v80, v113, v8
    v_and_b32 v81, v113, v9
    v_and_b32 v82, v113, v10
    v_and_b32 v83, v113, v11
    v_mfma_f32_16x16x32_bf16 v[72:75], v[32:35], v[76:79], 0
    v_and_b32 v76, v114, v8
    v_and_b32 v77, v114, v9
    v_and_b32 v78, v114, v10
    v_and_b32 v79, v114, v11
    v_mfma_f32_16x16x32_bf16 v[72:75], v[36:39], v[80:83], v[72:75]
    v_and_b32 v80, v115, v8
    v_and_b32 v81, v115, v9
    v_and_b32 v82, v115, v10
    v_and_b32 v83, v115, v11
    v_mfma_f32_16x16x32_bf16 v[72:75], v[40:43], v[76:79], v[72:75]
    v_and_b32 v76, v116, v8
    v_and_b32 v77, v116, v9
    v_and_b32 v78, v116, v10
    v_and_b32 v79, v116, v11
    v_mfma_f32_16x16x32_bf16 v[72:75], v[44:47], v[80:83], v[72:75]
    s_nop 0
    v_mfma_f32_16x16x32_bf16 v[72:75], v[48:51], v[76:79], v[72:75]
    s_nop 7
    v_mov_b32 v100, v72
    v_mov_b32 v101, v73
    v_mov_b32 v102, v74
    v_mov_b32 v103, v75
    v_permlane32_swap_b32 v72, v100
    v_permlane32_swap_b32 v73, v101
    v_permlane32_swap_b32 v74, v102
    v_permlane32_swap_b32 v75, v103
    v_add_f32_dpp v72, v100, v72 row_shl:8 row_mask:0xf bank_mask:0xf
    v_add_f32_dpp v73, v101, v73 row_shl:8 row_mask:0xf bank_mask:0xf
    v_add_f32_dpp v74, v102, v74 row_shl:8 row_mask:0xf bank_mask:0xf
    v_add_f32_dpp v75, v103, v75 row_shl:8 row_mask:0xf bank_mask:0xf
    v_mov_b32 v96, v72
    v_mov_b32 v97, v73
    s_nop 0
    v_mov_b32_dpp v96, v74 row_shr:8 row_mask:0xf bank_mask:0xc
    v_mov_b32_dpp v97, v75 row_shr:8 row_mask:0xf bank_mask:0xc
    s_add_u32 s59, s59, 4096
    s_mov_b64 s[62:63], exec
    s_mov_b64 exec, 0xffffffff
    buffer_store_dwordx4 v[96:99], v12, s[44:47], s59 offen sc1
    s_mov_b64 exec, s[62:63]
    s_branch L_exit
L_commA:
    s_setprio 3
    s_barrier
    s_mov_b32 s54, s5
    s_mul_i32 s55, s4, 7
    s_add_u32 s55, s55, s54
    v_and_b32 v112, 3, v1
    v_lshrrev_b32 v4, 1, v112
    s_lshl_b32 s56, s55, 1
    v_add_u32 v4, s56, v4
    v_and_b32 v4, 7, v4
    s_lshr_b32 s56, s55, 2
    s_lshl_b32 s56, s56, 5
    v_add_u32 v4, s56, v4
    v_and_b32 v5, 1, v112
    v_lshl_add_u32 v4, v5, 4, v4
    v_lshlrev_b32 v113, 1, v4
    v_lshlrev_b32 v114, 4, v112
    s_mov_b32 s40, s8
    s_mov_b32 s41, s9
    s_mov_b32 s42, 1152
    s_mov_b32 s43, 0x20000
    buffer_load_ushort v116, v113, s[40:43], 0 offen
    buffer_load_ushort v117, v113, s[40:43], 0 offen offset:16
    s_cmp_eq_u32 s54, 6
    s_cselect_b32 s57, 10, 9
    s_mul_i32 s56, s54, 9
    v_add_u32 v4, s56, v2
    v_mul_u32_u24 v6, 2560, v3
    v_lshl_add_u32 v5, v4, 5, v6
    v_bfe_u32 v4, v4, 3, 1
    v_lshl_add_u32 v4, v4, 6, v6
    v_add_u32 v4, 2048, v4
    s_mul_i32 s48, s4, 40960
    s_add_u32 s48, s48, 262144
    s_add_u32 s49, s48, 10240
    s_add_u32 s50, s48, 20480
    s_add_u32 s51, s48, 30720
    v_lshrrev_b32 v115, 2, v1
    v_mul_u32_u24 v115, 4608, v115
    v_add_u32 v115, v115, v114
    v_lshrrev_b32 v6, 2, v1
    v_mul_u32_u24 v118, 5120, v6
    v_add_u32 v118, v118, v114
    v_lshlrev_b32 v119, 4, v1
    s_waitcnt lgkmcnt(0)
    s_add_u32 s6, s6, 0x7f4a7c15
    s_add_u32 s7, s7, 0x9e3779b9
    v_mov_b32 v122, s6
    v_mov_b32 v123, s7
    v_mov_b32 v7, 0
    s_mov_b32 s61, 0x400000
Lw_42:
    ds_read_b32 v6, v7 offset:28
    s_waitcnt lgkmcnt(0)
    v_readfirstlane_b32 s60, v6
    s_nop 2
    s_cmp_ge_u32 s60, 1
    s_cbranch_scc1 Ld_43
    s_sub_u32 s61, s61, 1
    s_cbranch_scc1 L_abort
    s_sleep 1
    s_branch Lw_42
Ld_43:
    v_lshlrev_b32 v116, 16, v116
    v_cmp_gt_u32 vcc, s57, v2
    s_mov_b32 s56, 0x3fb8aa3b
    s_nop 1
    s_mov_b64 exec, vcc
    s_add_u32 s48, s48, 1900544
    s_add_u32 s49, s49, 1900544
    s_add_u32 s50, s50, 1900544
    s_add_u32 s51, s51, 1900544
    s_mov_b32 s64, 30
Lhl_44:
    buffer_load_dwordx4 v[16:19], v5, s[44:47], s48 offen sc1
    buffer_load_dwordx4 v[20:23], v5, s[44:47], s48 offen offset:16 sc1
    buffer_load_dwordx4 v[24:27], v4, s[44:47], s48 offen sc1
    buffer_load_dwordx4 v[28:31], v5, s[44:47], s49 offen sc1
    buffer_load_dwordx4 v[32:35], v5, s[44:47], s49 offen offset:16 sc1
    buffer_load_dwordx4 v[36:39], v4, s[44:47], s49 offen sc1
    buffer_load_dwordx4 v[40:43], v5, s[44:47], s50 offen sc1
    buffer_load_dwordx4 v[44:47], v5, s[44:47], s50 offen offset:16 sc1
    buffer_load_dwordx4 v[48:51], v4, s[44:47], s50 offen sc1
    buffer_load_dwordx4 v[52:55], v5, s[44:47], s51 offen sc1
    buffer_load_dwordx4 v[56:59], v5, s[44:47], s51 offen offset:16 sc1
    buffer_load_dwordx4 v[60:63], v4, s[44:47], s51 offen sc1
    s_waitcnt vmcnt(0)
    v_cmp_ne_u64 s[66:67], s[6:7], v[18:19]
    v_cmp_ne_u64 s[68:69], s[6:7], v[22:23]
    v_cmp_ne_u64 s[70:71], s[6:7], v[26:27]
    v_cmp_ne_u64 s[72:73], s[6:7], v[30:31]
    v_cmp_ne_u64 s[74:75], s[6:7], v[34:35]
    v_cmp_ne_u64 vcc, s[6:7], v[38:39]
    s_nop 2
    s_or_b64 vcc, vcc, s[66:67]
    s_or_b64 vcc, vcc, s[68:69]
    s_or_b64 vcc, vcc, s[70:71]
    s_or_b64 vcc, vcc, s[72:73]
    s_or_b64 vcc, vcc, s[74:75]
    s_mov_b64 s[62:63], vcc
    v_cmp_ne_u64 s[66:67], s[6:7], v[42:43]
    v_cmp_ne_u64 s[68:69], s[6:7], v[46:47]
    v_cmp_ne_u64 s[70:71], s[6:7], v[50:51]
    v_cmp_ne_u64 s[72:73], s[6:7], v[54:55]
    v_cmp_ne_u64 s[74:75], s[6:7], v[58:59]
    v_cmp_ne_u64 vcc, s[6:7], v[62:63]
    s_nop 2
    s_or_b64 vcc, vcc, s[66:67]
    s_or_b64 vcc, vcc, s[68:69]
    s_or_b64 vcc, vcc, s[70:71]
    s_or_b64 vcc, vcc, s[72:73]
    s_or_b64 vcc, vcc, s[74:75]
    s_or_b64 vcc, vcc, s[62:63]
    s_cbranch_vccz Lhl_45
    s_sub_u32 s64, s64, 1
    s_cbranch_scc0 Lhl_44
    s_sub_u32 s48, s48, 1900544
    s_sub_u32 s49, s49, 1900544
    s_sub_u32 s50, s50, 1900544
    s_sub_u32 s51, s51, 1900544
    s_mov_b32 s64, 0x8000
Lp_47:
    buffer_load_dwordx4 v[16:19], v5, s[44:47], s48 offen sc1
    buffer_load_dwordx4 v[20:23], v5, s[44:47], s48 offen offset:16 sc1
    buffer_load_dwordx4 v[24:27], v4, s[44:47], s48 offen sc1
    buffer_load_dwordx4 v[28:31], v5, s[44:47], s49 offen sc1
    buffer_load_dwordx4 v[32:35], v5, s[44:47], s49 offen offset:16 sc1
    buffer_load_dwordx4 v[36:39], v4, s[44:47], s49 offen sc1
    buffer_load_dwordx4 v[40:43], v5, s[44:47], s50 offen sc1
    buffer_load_dwordx4 v[44:47], v5, s[44:47], s50 offen offset:16 sc1
    buffer_load_dwordx4 v[48:51], v4, s[44:47], s50 offen sc1
    buffer_load_dwordx4 v[52:55], v5, s[44:47], s51 offen sc1
    buffer_load_dwordx4 v[56:59], v5, s[44:47], s51 offen offset:16 sc1
    buffer_load_dwordx4 v[60:63], v4, s[44:47], s51 offen sc1
    s_waitcnt vmcnt(0)
    v_cmp_ne_u64 s[66:67], s[6:7], v[18:19]
    v_cmp_ne_u64 s[68:69], s[6:7], v[22:23]
    v_cmp_ne_u64 s[70:71], s[6:7], v[26:27]
    v_cmp_ne_u64 s[72:73], s[6:7], v[30:31]
    v_cmp_ne_u64 s[74:75], s[6:7], v[34:35]
    v_cmp_ne_u64 vcc, s[6:7], v[38:39]
    s_nop 2
    s_or_b64 vcc, vcc, s[66:67]
    s_or_b64 vcc, vcc, s[68:69]
    s_or_b64 vcc, vcc, s[70:71]
    s_or_b64 vcc, vcc, s[72:73]
    s_or_b64 vcc, vcc, s[74:75]
    s_mov_b64 s[62:63], vcc
    v_cmp_ne_u64 s[66:67], s[6:7], v[42:43]
    v_cmp_ne_u64 s[68:69], s[6:7], v[46:47]
    v_cmp_ne_u64 s[70:71], s[6:7], v[50:51]
    v_cmp_ne_u64 s[72:73], s[6:7], v[54:55]
    v_cmp_ne_u64 s[74:75], s[6:7], v[58:59]
    v_cmp_ne_u64 vcc, s[6:7], v[62:63]
    s_nop 2
    s_or_b64 vcc, vcc, s[66:67]
    s_or_b64 vcc, vcc, s[68:69]
    s_or_b64 vcc, vcc, s[70:71]
    s_or_b64 vcc, vcc, s[72:73]
    s_or_b64 vcc, vcc, s[74:75]
    s_or_b64 vcc, vcc, s[62:63]
    s_sub_u32 s64, s64, 1
    s_cbranch_scc1 L_abort
    s_cbranch_vccnz Lp_47
Lhl_45:
    v_max3_f32 v12, v24, v36, v48
    v_max_f32 v12, v12, v60
    v_mov_b32 v13, v12
    s_nop 1
    v_permlane16_swap_b32 v12, v13
    v_max_f32 v12, v12, v13
    v_mov_b32 v13, v12
    s_nop 1
    v_permlane32_swap_b32 v12, v13
    v_max_f32 v12, v12, v13
    v_sub_f32 v26, v24, v12
    v_sub_f32 v38, v36, v12
    v_sub_f32 v50, v48, v12
    v_sub_f32 v62, v60, v12
    v_mul_f32 v26, s56, v26
    v_mul_f32 v38, s56, v38
    v_mul_f32 v50, s56, v50
    v_mul_f32 v62, s56, v62
    v_exp_f32 v26, v26
    v_exp_f32 v38, v38
    v_exp_f32 v50, v50
    v_exp_f32 v62, v62
    v_mul_f32 v14, v26, v25
    v_mul_f32 v8, v26, v16
    v_mul_f32 v9, v26, v17
    v_mul_f32 v10, v26, v20
    v_mul_f32 v11, v26, v21
    v_fmac_f32 v14, v38, v37
    v_fmac_f32 v8, v38, v28
    v_fmac_f32 v9, v38, v29
    v_fmac_f32 v10, v38, v32
    v_fmac_f32 v11, v38, v33
    v_fmac_f32 v14, v50, v49
    v_fmac_f32 v8, v50, v40
    v_fmac_f32 v9, v50, v41
    v_fmac_f32 v10, v50, v44
    v_fmac_f32 v11, v50, v45
    v_fmac_f32 v14, v62, v61
    v_fmac_f32 v8, v62, v52
    v_fmac_f32 v9, v62, v53
    v_fmac_f32 v10, v62, v56
    v_fmac_f32 v11, v62, v57
    v_mov_b32 v18, v14
    v_mov_b32 v19, v8
    v_mov_b32 v22, v9
    v_mov_b32 v23, v10
    v_mov_b32 v27, v11
    v_permlane16_swap_b32 v14, v18
    v_permlane16_swap_b32 v8, v19
    v_permlane16_swap_b32 v9, v22
    v_permlane16_swap_b32 v10, v23
    v_permlane16_swap_b32 v11, v27
    v_add_f32 v14, v14, v18
    v_add_f32 v8, v8, v19
    v_add_f32 v9, v9, v22
    v_add_f32 v10, v10, v23
    v_add_f32 v11, v11, v27
    v_mov_b32 v18, v14
    v_mov_b32 v19, v8
    v_mov_b32 v22, v9
    v_mov_b32 v23, v10
    v_mov_b32 v27, v11
    v_permlane32_swap_b32 v14, v18
    v_permlane32_swap_b32 v8, v19
    v_permlane32_swap_b32 v9, v22
    v_permlane32_swap_b32 v10, v23
    v_permlane32_swap_b32 v11, v27
    v_add_f32 v14, v14, v18
    v_add_f32 v8, v8, v19
    v_add_f32 v9, v9, v22
    v_add_f32 v10, v10, v23
    v_add_f32 v11, v11, v27
    v_rcp_f32 v14, v14
    s_nop 0
    v_mul_f32 v8, v8, v14
    v_mul_f32 v9, v9, v14
    v_mul_f32 v10, v10, v14
    v_mul_f32 v11, v11, v14
    v_cvt_pk_bf16_f32 v8, v8, v8
    v_cvt_pk_bf16_f32 v9, v9, v9
    v_cvt_pk_bf16_f32 v10, v10, v10
    v_cvt_pk_bf16_f32 v11, v11, v11
    s_and_b32 exec_lo, exec_lo, 0xffff
    s_mov_b32 exec_hi, 0
    ds_write_b128 v119, v[8:11] offset:4352
    s_mov_b64 exec, -1
    s_cmp_ge_u32 s55, 72
    s_cselect_b32 s65, 1, 0
    s_lshl_b32 s56, s55, 6
    s_add_u32 s48, s56, 917504
    s_add_u32 s49, s48, 73728
    s_add_u32 s50, s49, 73728
    s_add_u32 s51, s50, 73728
    s_add_u32 s52, s51, 73728
    s_add_u32 s53, s52, 73728
    s_add_u32 s54, s53, 73728
    s_lshl_b32 s57, s55, 6
    s_add_u32 s58, s57, 131072
    v_lshlrev_b32 v117, 16, v117
    s_waitcnt lgkmcnt(0)
    s_barrier
    s_cmp_lg_u32 s65, 0
    s_cbranch_scc1 L_exit
    s_mov_b32 s64, 0x8000
Lp_49:
    buffer_load_dwordx4 v[44:47], v114, s[44:47], s58 offen sc1
    buffer_load_dwordx4 v[16:19], v115, s[44:47], s48 offen sc1
    buffer_load_dwordx4 v[20:23], v115, s[44:47], s49 offen sc1
    buffer_load_dwordx4 v[24:27], v115, s[44:47], s50 offen sc1
    buffer_load_dwordx4 v[28:31], v115, s[44:47], s51 offen sc1
    buffer_load_dwordx4 v[32:35], v115, s[44:47], s52 offen sc1
    buffer_load_dwordx4 v[36:39], v115, s[44:47], s53 offen sc1
    buffer_load_dwordx4 v[40:43], v115, s[44:47], s54 offen sc1
    s_waitcnt vmcnt(0)
    v_cmp_ne_u64 s[66:67], s[6:7], v[18:19]
    v_cmp_ne_u64 s[68:69], s[6:7], v[22:23]
    v_cmp_ne_u64 s[70:71], s[6:7], v[26:27]
    v_cmp_ne_u64 s[72:73], s[6:7], v[30:31]
    v_cmp_ne_u64 s[74:75], s[6:7], v[34:35]
    v_cmp_ne_u64 s[76:77], s[6:7], v[38:39]
    v_cmp_ne_u64 s[78:79], s[6:7], v[42:43]
    v_cmp_ne_u64 vcc, s[6:7], v[46:47]
    s_nop 2
    s_or_b64 vcc, vcc, s[66:67]
    s_or_b64 vcc, vcc, s[68:69]
    s_or_b64 vcc, vcc, s[70:71]
    s_or_b64 vcc, vcc, s[72:73]
    s_or_b64 vcc, vcc, s[74:75]
    s_or_b64 vcc, vcc, s[76:77]
    s_or_b64 vcc, vcc, s[78:79]
    s_sub_u32 s64, s64, 1
    s_cbranch_scc1 L_abort
    s_cbranch_vccnz Lp_49
    v_add_f32 v16, v16, v20
    v_add_f32 v17, v17, v21
    v_add_f32 v24, v24, v28
    v_add_f32 v25, v25, v29
    v_add_f32 v32, v32, v36
    v_add_f32 v33, v33, v37
    v_add_f32 v16, v16, v24
    v_add_f32 v17, v17, v25
    v_add_f32 v32, v32, v40
    v_add_f32 v33, v33, v41
    v_add_f32 v16, v16, v32
    v_add_f32 v17, v17, v33
    s_nop 0
    v_add_f32_dpp v16, v16, v16 row_ror:4 row_mask:0xf bank_mask:0xf
    v_add_f32_dpp v17, v17, v17 row_ror:4 row_mask:0xf bank_mask:0xf
    s_nop 0
    v_add_f32_dpp v16, v16, v16 row_ror:8 row_mask:0xf bank_mask:0xf
    v_add_f32_dpp v17, v17, v17 row_ror:8 row_mask:0xf bank_mask:0xf
    v_mov_b32 v18, v16
    v_mov_b32 v19, v17
    s_nop 0
    v_permlane16_swap_b32 v16, v18
    v_permlane16_swap_b32 v17, v19
    v_add_f32 v16, v16, v18
    v_add_f32 v17, v17, v19
    v_mov_b32 v18, v16
    v_mov_b32 v19, v17
    s_nop 0
    v_permlane32_swap_b32 v16, v18
    v_permlane32_swap_b32 v17, v19
    v_add_f32 v16, v16, v18
    v_add_f32 v17, v17, v19
    v_cvt_pk_bf16_f32 v16, v16, v16
    v_cvt_pk_bf16_f32 v17, v17, v17
    v_lshlrev_b32 v16, 16, v16
    v_lshlrev_b32 v17, 16, v17
    v_mul_f32 v16, v16, v44
    v_mul_f32 v17, v17, v45
    v_cvt_pk_bf16_f32 v16, v16, v16
    v_cvt_pk_bf16_f32 v17, v17, v17
    v_lshlrev_b32 v16, 16, v16
    v_lshlrev_b32 v17, 16, v17
    v_add_f32 v120, v16, v116
    v_add_f32 v121, v17, v117
    v_cvt_pk_bf16_f32 v120, v120, v120
    v_cvt_pk_bf16_f32 v121, v121, v121
    v_lshlrev_b32 v120, 16, v120
    v_lshlrev_b32 v121, 16, v121
    s_add_u32 s59, s57, 163840
    s_mov_b64 exec, 0xffffffff
    buffer_store_dwordx4 v[120:123], v118, s[44:47], s59 offen sc1
    s_mov_b64 exec, -1
    s_add_u32 s48, s56, 1441792
    s_add_u32 s49, s48, 73728
    s_add_u32 s50, s49, 73728
    s_add_u32 s51, s50, 73728
    s_add_u32 s52, s51, 73728
    s_add_u32 s53, s52, 73728
    s_add_u32 s54, s53, 73728
    s_add_u32 s55, s54, 73728
    s_add_u32 s56, s55, 73728
    s_add_u32 s58, s57, 144896
    s_mov_b32 s40, s30
    s_mov_b32 s41, s31
    s_mov_b32 s42, 1152
    s_mov_b32 s43, 0x20000
    s_mov_b32 s64, 0x8000
Lp_51:
    buffer_load_dwordx4 v[60:63], v114, s[44:47], s58 offen sc1
    buffer_load_dwordx4 v[24:27], v115, s[44:47], s48 offen sc1
    buffer_load_dwordx4 v[28:31], v115, s[44:47], s49 offen sc1
    buffer_load_dwordx4 v[32:35], v115, s[44:47], s50 offen sc1
    buffer_load_dwordx4 v[36:39], v115, s[44:47], s51 offen sc1
    buffer_load_dwordx4 v[40:43], v115, s[44:47], s52 offen sc1
    buffer_load_dwordx4 v[44:47], v115, s[44:47], s53 offen sc1
    buffer_load_dwordx4 v[48:51], v115, s[44:47], s54 offen sc1
    buffer_load_dwordx4 v[52:55], v115, s[44:47], s55 offen sc1
    buffer_load_dwordx4 v[56:59], v115, s[44:47], s56 offen sc1
    s_waitcnt vmcnt(0)
    v_cmp_ne_u64 s[66:67], s[6:7], v[26:27]
    v_cmp_ne_u64 s[68:69], s[6:7], v[30:31]
    v_cmp_ne_u64 s[70:71], s[6:7], v[34:35]
    v_cmp_ne_u64 s[72:73], s[6:7], v[38:39]
    v_cmp_ne_u64 vcc, s[6:7], v[42:43]
    s_nop 2
    s_or_b64 vcc, vcc, s[66:67]
    s_or_b64 vcc, vcc, s[68:69]
    s_or_b64 vcc, vcc, s[70:71]
    s_or_b64 vcc, vcc, s[72:73]
    s_mov_b64 s[62:63], vcc
    v_cmp_ne_u64 s[66:67], s[6:7], v[46:47]
    v_cmp_ne_u64 s[68:69], s[6:7], v[50:51]
    v_cmp_ne_u64 s[70:71], s[6:7], v[54:55]
    v_cmp_ne_u64 s[72:73], s[6:7], v[58:59]
    v_cmp_ne_u64 vcc, s[6:7], v[62:63]
    s_nop 2
    s_or_b64 vcc, vcc, s[66:67]
    s_or_b64 vcc, vcc, s[68:69]
    s_or_b64 vcc, vcc, s[70:71]
    s_or_b64 vcc, vcc, s[72:73]
    s_or_b64 vcc, vcc, s[62:63]
    s_sub_u32 s64, s64, 1
    s_cbranch_scc1 L_abort
    s_cbranch_vccnz Lp_51
    v_add_f32 v24, v24, v28
    v_add_f32 v25, v25, v29
    v_add_f32 v32, v32, v36
    v_add_f32 v33, v33, v37
    v_add_f32 v40, v40, v44
    v_add_f32 v41, v41, v45
    v_add_f32 v48, v48, v52
    v_add_f32 v49, v49, v53
    v_add_f32 v24, v24, v32
    v_add_f32 v25, v25, v33
    v_add_f32 v40, v40, v48
    v_add_f32 v41, v41, v49
    v_add_f32 v24, v24, v40
    v_add_f32 v25, v25, v41
    v_add_f32 v24, v24, v56
    v_add_f32 v25, v25, v57
    s_nop 0
    v_add_f32_dpp v24, v24, v24 row_ror:4 row_mask:0xf bank_mask:0xf
    v_add_f32_dpp v25, v25, v25 row_ror:4 row_mask:0xf bank_mask:0xf
    s_nop 0
    v_add_f32_dpp v24, v24, v24 row_ror:8 row_mask:0xf bank_mask:0xf
    v_add_f32_dpp v25, v25, v25 row_ror:8 row_mask:0xf bank_mask:0xf
    v_mov_b32 v26, v24
    v_mov_b32 v27, v25
    s_nop 0
    v_permlane16_swap_b32 v24, v26
    v_permlane16_swap_b32 v25, v27
    v_add_f32 v24, v24, v26
    v_add_f32 v25, v25, v27
    v_mov_b32 v26, v24
    v_mov_b32 v27, v25
    s_nop 0
    v_permlane32_swap_b32 v24, v26
    v_permlane32_swap_b32 v25, v27
    v_add_f32 v24, v24, v26
    v_add_f32 v25, v25, v27
    v_cvt_pk_bf16_f32 v24, v24, v24
    v_cvt_pk_bf16_f32 v25, v25, v25
    v_lshlrev_b32 v24, 16, v24
    v_lshlrev_b32 v25, 16, v25
    v_mul_f32 v24, v24, v60
    v_mul_f32 v25, v25, v61
    v_cvt_pk_bf16_f32 v24, v24, v24
    v_cvt_pk_bf16_f32 v25, v25, v25
    v_lshlrev_b32 v24, 16, v24
    v_lshlrev_b32 v25, 16, v25
    v_add_f32 v8, v24, v120
    v_add_f32 v9, v25, v121
    v_cvt_pk_bf16_f32 v8, v8, v8
    v_cvt_pk_bf16_f32 v9, v9, v9
    s_mov_b64 exec, 0xf
    buffer_store_short v8, v113, s[40:43], 0 offen
    buffer_store_short v9, v113, s[40:43], 0 offen offset:16
    s_mov_b64 exec, -1
    s_mul_i32 s55, s4, 7
    s_add_u32 s55, s55, s5
    s_cmp_lg_u32 s55, 0
    s_cbranch_scc1 L_exit
    v_mov_b32 v4, 0
    v_mov_b32 v8, s6
    v_mov_b32 v9, s7
    s_mov_b64 exec, 1
    buffer_store_dwordx2 v[8:9], v4, s[44:47], 0 offen sc1
    s_mov_b64 exec, -1
    s_branch L_exit
L_gu:
    s_cmp_lg_u32 s3, 1
    s_cbranch_scc1 L_gu_nopf
    s_getpc_b64 s[52:53]
L_pc:
    s_sub_u32 s52, s52, L_pc-adaLN_cond__sliding_block_cached__geglu_ffn__decode_kernel
    s_subb_u32 s53, s53, 0
    v_lshlrev_b32 v4, 7, v1
    v_cmp_gt_u32 vcc, L_codeend-adaLN_cond__sliding_block_cached__geglu_ffn__decode_kernel, v4
    s_nop 2
    s_and_saveexec_b64 s[62:63], vcc
    global_load_dword v16, v4, s[52:53]
    s_mov_b64 exec, s[62:63]
    v_add_u32 v4, 0x2000, v4
    v_cmp_gt_u32 vcc, L_codeend-adaLN_cond__sliding_block_cached__geglu_ffn__decode_kernel, v4
    s_nop 2
    s_and_saveexec_b64 s[62:63], vcc
    global_load_dword v17, v4, s[52:53]
    s_mov_b64 exec, s[62:63]
    v_add_u32 v4, 0x2000, v4
    v_cmp_gt_u32 vcc, L_codeend-adaLN_cond__sliding_block_cached__geglu_ffn__decode_kernel, v4
    s_nop 2
    s_and_saveexec_b64 s[62:63], vcc
    global_load_dword v18, v4, s[52:53]
    s_mov_b64 exec, s[62:63]
    v_add_u32 v4, 0x2000, v4
    v_cmp_gt_u32 vcc, L_codeend-adaLN_cond__sliding_block_cached__geglu_ffn__decode_kernel, v4
    s_nop 2
    s_and_saveexec_b64 s[62:63], vcc
    global_load_dword v19, v4, s[52:53]
    s_mov_b64 exec, s[62:63]
    v_add_u32 v4, 0x2000, v4
L_gu_nopf:
    s_sub_u32 s53, s3, 1
    s_lshr_b32 s54, s53, 1
    s_and_b32 s55, s53, 1
    s_cmp_eq_u32 s54, 0
    s_cselect_b32 s36, s20, s22
    s_cselect_b32 s37, s21, s23
    s_mov_b32 s38, 5308416
    s_mov_b32 s39, 0x20000
    s_mul_i32 s56, s4, 9
    s_add_u32 s56, s56, s5
    s_sub_u32 s56, s56, 7
    s_lshl_b32 s56, s56, 6
    s_mul_i32 s57, s55, 2654208
    s_add_u32 s56, s56, s57
    s_mov_b32 s58, 0x05040100
    s_mov_b32 s59, 0x07060302
    v_mul_u32_u24 v4, 18432, v3
    v_lshl_add_u32 v4, v2, 2, v4
    s_barrier
    v_mov_b32 v7, 0
    v_mov_b32 v6, 1
    s_mov_b64 s[62:63], exec
    s_mov_b64 exec, 1
    ds_add_u32 v7, v6 offset:40
    s_mov_b64 exec, s[62:63]
    s_waitcnt lgkmcnt(0)
    s_add_u32 s6, s6, 0x7f4a7c15
    s_add_u32 s7, s7, 0x9e3779b9
    s_cmp_gt_u32 s3, 4
    s_cbranch_scc1 L_gu2
    s_lshl_b32 s38, s4, 10
    s_lshl_b32 s39, s3, 8
    s_add_u32 s38, s38, s39
    s_add_u32 s38, s38, 32512
    s_add_u32 s36, s34, s38
    s_addc_u32 s37, s35, 0
    s_mov_b32 s42, 0x40000
    s_branch Lqf_55
Lqf_53:
    s_sleep 4
Lqf_55:
    s_load_dwordx2 s[40:41], s[36:37], 128 glc
    s_load_dwordx16 s[48:63], s[36:37], 0 glc
    s_load_dwordx16 s[64:79], s[36:37], 64 glc
    s_sub_u32 s42, s42, 1
    s_cbranch_scc1 L_abort
    s_waitcnt lgkmcnt(0)
    s_cmp_lg_u32 s41, s7
    s_cbranch_scc1 Lqf_53
    s_add_u32 s43, s48, s7
    s_add_u32 s43, s43, s49
    s_add_u32 s43, s43, s50
    s_add_u32 s43, s43, s51
    s_add_u32 s43, s43, s52
    s_add_u32 s43, s43, s53
    s_add_u32 s43, s43, s54
    s_add_u32 s43, s43, s55
    s_add_u32 s43, s43, s56
    s_add_u32 s43, s43, s57
    s_add_u32 s43, s43, s58
    s_add_u32 s43, s43, s59
    s_add_u32 s43, s43, s60
    s_add_u32 s43, s43, s61
    s_add_u32 s43, s43, s62
    s_add_u32 s43, s43, s63
    s_add_u32 s43, s43, s64
    s_add_u32 s43, s43, s65
    s_add_u32 s43, s43, s66
    s_add_u32 s43, s43, s67
    s_add_u32 s43, s43, s68
    s_add_u32 s43, s43, s69
    s_add_u32 s43, s43, s70
    s_add_u32 s43, s43, s71
    s_add_u32 s43, s43, s72
    s_add_u32 s43, s43, s73
    s_add_u32 s43, s43, s74
    s_add_u32 s43, s43, s75
    s_add_u32 s43, s43, s76
    s_add_u32 s43, s43, s77
    s_add_u32 s43, s43, s78
    s_add_u32 s43, s43, s79
    s_cmp_lg_u32 s43, s40
    s_cbranch_scc1 Lqf_55
    v_writelane_b32 v20, s48, 0
    v_writelane_b32 v20, s49, 1
    v_writelane_b32 v20, s50, 2
    v_writelane_b32 v20, s51, 3
    v_writelane_b32 v20, s52, 4
    v_writelane_b32 v20, s53, 5
    v_writelane_b32 v20, s54, 6
    v_writelane_b32 v20, s55, 7
    v_writelane_b32 v20, s56, 8
    v_writelane_b32 v20, s57, 9
    v_writelane_b32 v20, s58, 10
    v_writelane_b32 v20, s59, 11
    v_writelane_b32 v20, s60, 12
    v_writelane_b32 v20, s61, 13
    v_writelane_b32 v20, s62, 14
    v_writelane_b32 v20, s63, 15
    v_writelane_b32 v20, s64, 16
    v_writelane_b32 v20, s65, 17
    v_writelane_b32 v20, s66, 18
    v_writelane_b32 v20, s67, 19
    v_writelane_b32 v20, s68, 20
    v_writelane_b32 v20, s69, 21
    v_writelane_b32 v20, s70, 22
    v_writelane_b32 v20, s71, 23
    v_writelane_b32 v20, s72, 24
    v_writelane_b32 v20, s73, 25
    v_writelane_b32 v20, s74, 26
    v_writelane_b32 v20, s75, 27
    v_writelane_b32 v20, s76, 28
    v_writelane_b32 v20, s77, 29
    v_writelane_b32 v20, s78, 30
    v_writelane_b32 v20, s79, 31
    v_and_b32 v21, 3, v1
    v_lshlrev_b32 v21, 2, v21
    v_bfe_u32 v22, v1, 2, 2
    v_add_u32 v21, v21, v22
    v_and_b32 v22, 16, v1
    v_add_u32 v21, v21, v22
    v_lshlrev_b32 v21, 2, v21
    s_lshl_b32 s38, s3, 7
    v_add_u32 v21, s38, v21
    s_mov_b64 exec, 0xffffffff
    ds_write_b32 v21, v20 offset:384
    s_mov_b64 exec, -1
    s_mov_b32 s44, s34
    s_mov_b32 s45, s35
    s_mov_b32 s46, 1073741824
    s_mov_b32 s47, 0x20000
    v_mov_b32 v7, 0
    v_mov_b32 v6, 1
    s_mov_b64 s[62:63], exec
    s_mov_b64 exec, 1
    ds_add_u32 v7, v6 offset:0
    s_mov_b64 exec, s[62:63]
L_gu2:
    s_sub_u32 s53, s3, 1
    s_lshr_b32 s54, s53, 1
    s_and_b32 s55, s53, 1
    s_cmp_eq_u32 s54, 0
    s_cselect_b32 s36, s20, s22
    s_cselect_b32 s37, s21, s23
    s_mov_b32 s38, 5308416
    s_mov_b32 s39, 0x20000
    s_mul_i32 s56, s4, 9
    s_add_u32 s56, s56, s5
    s_sub_u32 s56, s56, 7
    s_lshl_b32 s56, s56, 6
    s_mul_i32 s57, s55, 2654208
    s_add_u32 s56, s56, s57
    s_mov_b32 s58, 0x05040100
    s_mov_b32 s59, 0x07060302
    s_waitcnt vmcnt(0)
    v_mov_b32 v7, 0
    s_mov_b32 s61, 0x400000
Lw_56:
    ds_read_b32 v6, v7 offset:4
    s_waitcnt lgkmcnt(0)
    v_readfirstlane_b32 s60, v6
    s_nop 2
    s_cmp_ge_u32 s60, 12
    s_cbranch_scc1 Ld_57
    s_sub_u32 s61, s61, 1
    s_cbranch_scc1 L_abort
    s_sleep 2
    s_branch Lw_56
Ld_57:
    s_add_u32 s57, s56, 0
    buffer_load_dword v32, v4, s[36:39], s57 offen nt
    s_add_u32 s57, s56, 73728
    buffer_load_dword v33, v4, s[36:39], s57 offen nt
    s_add_u32 s57, s56, 147456
    buffer_load_dword v34, v4, s[36:39], s57 offen nt
    s_add_u32 s57, s56, 221184
    buffer_load_dword v35, v4, s[36:39], s57 offen nt
    s_add_u32 s57, s56, 9216
    buffer_load_dword v36, v4, s[36:39], s57 offen nt
    s_add_u32 s57, s56, 82944
    buffer_load_dword v37, v4, s[36:39], s57 offen nt
    s_add_u32 s57, s56, 156672
    buffer_load_dword v38, v4, s[36:39], s57 offen nt
    s_add_u32 s57, s56, 230400
    buffer_load_dword v39, v4, s[36:39], s57 offen nt
    v_mov_b32 v7, 0
    ds_read_b32 v6, v7 offset:28
    s_waitcnt lgkmcnt(0)
    v_readfirstlane_b32 s60, v6
    s_nop 2
    s_cmp_lg_u32 s60, 0
    s_cbranch_scc1 Lgd_58
    s_waitcnt vmcnt(4)
Lgd_58:
    s_add_u32 s57, s56, 294912
    buffer_load_dword v40, v4, s[36:39], s57 offen nt
    s_add_u32 s57, s56, 368640
    buffer_load_dword v41, v4, s[36:39], s57 offen nt
    s_add_u32 s57, s56, 442368
    buffer_load_dword v42, v4, s[36:39], s57 offen nt
    s_add_u32 s57, s56, 516096
    buffer_load_dword v43, v4, s[36:39], s57 offen nt
    s_add_u32 s57, s56, 304128
    buffer_load_dword v44, v4, s[36:39], s57 offen nt
    s_add_u32 s57, s56, 377856
    buffer_load_dword v45, v4, s[36:39], s57 offen nt
    s_add_u32 s57, s56, 451584
    buffer_load_dword v46, v4, s[36:39], s57 offen nt
    s_add_u32 s57, s56, 525312
    buffer_load_dword v47, v4, s[36:39], s57 offen nt
    v_mov_b32 v7, 0
    ds_read_b32 v6, v7 offset:28
    s_waitcnt lgkmcnt(0)
    v_readfirstlane_b32 s60, v6
    s_nop 2
    s_cmp_lg_u32 s60, 0
    s_cbranch_scc1 Lgd_59
    s_waitcnt vmcnt(4)
Lgd_59:
    s_add_u32 s57, s56, 589824
    buffer_load_dword v48, v4, s[36:39], s57 offen nt
    s_add_u32 s57, s56, 663552
    buffer_load_dword v49, v4, s[36:39], s57 offen nt
    s_add_u32 s57, s56, 737280
    buffer_load_dword v50, v4, s[36:39], s57 offen nt
    s_add_u32 s57, s56, 811008
    buffer_load_dword v51, v4, s[36:39], s57 offen nt
    s_add_u32 s57, s56, 599040
    buffer_load_dword v52, v4, s[36:39], s57 offen nt
    s_add_u32 s57, s56, 672768
    buffer_load_dword v53, v4, s[36:39], s57 offen nt
    s_add_u32 s57, s56, 746496
    buffer_load_dword v54, v4, s[36:39], s57 offen nt
    s_add_u32 s57, s56, 820224
    buffer_load_dword v55, v4, s[36:39], s57 offen nt
    v_mov_b32 v7, 0
    ds_read_b32 v6, v7 offset:28
    s_waitcnt lgkmcnt(0)
    v_readfirstlane_b32 s60, v6
    s_nop 2
    s_cmp_lg_u32 s60, 0
    s_cbranch_scc1 Lgd_60
    s_waitcnt vmcnt(4)
Lgd_60:
    s_add_u32 s57, s56, 884736
    buffer_load_dword v56, v4, s[36:39], s57 offen nt
    s_add_u32 s57, s56, 958464
    buffer_load_dword v57, v4, s[36:39], s57 offen nt
    s_add_u32 s57, s56, 1032192
    buffer_load_dword v58, v4, s[36:39], s57 offen nt
    s_add_u32 s57, s56, 1105920
    buffer_load_dword v59, v4, s[36:39], s57 offen nt
    s_add_u32 s57, s56, 893952
    buffer_load_dword v60, v4, s[36:39], s57 offen nt
    s_add_u32 s57, s56, 967680
    buffer_load_dword v61, v4, s[36:39], s57 offen nt
    s_add_u32 s57, s56, 1041408
    buffer_load_dword v62, v4, s[36:39], s57 offen nt
    s_add_u32 s57, s56, 1115136
    buffer_load_dword v63, v4, s[36:39], s57 offen nt
    v_mov_b32 v7, 0
    ds_read_b32 v6, v7 offset:28
    s_waitcnt lgkmcnt(0)
    v_readfirstlane_b32 s60, v6
    s_nop 2
    s_cmp_lg_u32 s60, 0
    s_cbranch_scc1 Lgd_61
    s_waitcnt vmcnt(4)
Lgd_61:
    s_add_u32 s57, s56, 1179648
    buffer_load_dword v64, v4, s[36:39], s57 offen nt
    s_add_u32 s57, s56, 1253376
    buffer_load_dword v65, v4, s[36:39], s57 offen nt
    s_add_u32 s57, s56, 1327104
    buffer_load_dword v66, v4, s[36:39], s57 offen nt
    s_add_u32 s57, s56, 1400832
    buffer_load_dword v67, v4, s[36:39], s57 offen nt
    s_add_u32 s57, s56, 1188864
    buffer_load_dword v68, v4, s[36:39], s57 offen nt
    s_add_u32 s57, s56, 1262592
    buffer_load_dword v69, v4, s[36:39], s57 offen nt
    s_add_u32 s57, s56, 1336320
    buffer_load_dword v70, v4, s[36:39], s57 offen nt
    s_add_u32 s57, s56, 1410048
    buffer_load_dword v71, v4, s[36:39], s57 offen nt
    s_waitcnt vmcnt(32)
    v_perm_b32 v24, v33, v32, s58
    v_perm_b32 v28, v33, v32, s59
    v_perm_b32 v25, v35, v34, s58
    v_perm_b32 v29, v35, v34, s59
    v_perm_b32 v26, v37, v36, s58
    v_perm_b32 v30, v37, v36, s59
    v_perm_b32 v27, v39, v38, s58
    v_perm_b32 v31, v39, v38, s59
    v_mov_b32 v7, 0
    ds_read_b32 v6, v7 offset:28
    s_waitcnt lgkmcnt(0)
    v_readfirstlane_b32 s60, v6
    s_nop 2
    s_cmp_lg_u32 s60, 0
    s_cbranch_scc1 Lgd_62
    s_waitcnt vmcnt(4)
Lgd_62:
    s_add_u32 s57, s56, 1474560
    buffer_load_dword v72, v4, s[36:39], s57 offen nt
    s_add_u32 s57, s56, 1548288
    buffer_load_dword v73, v4, s[36:39], s57 offen nt
    s_add_u32 s57, s56, 1622016
    buffer_load_dword v74, v4, s[36:39], s57 offen nt
    s_add_u32 s57, s56, 1695744
    buffer_load_dword v75, v4, s[36:39], s57 offen nt
    s_add_u32 s57, s56, 1483776
    buffer_load_dword v76, v4, s[36:39], s57 offen nt
    s_add_u32 s57, s56, 1557504
    buffer_load_dword v77, v4, s[36:39], s57 offen nt
    s_add_u32 s57, s56, 1631232
    buffer_load_dword v78, v4, s[36:39], s57 offen nt
    s_add_u32 s57, s56, 1704960
    buffer_load_dword v79, v4, s[36:39], s57 offen nt
    s_waitcnt vmcnt(32)
    v_perm_b32 v32, v41, v40, s58
    v_perm_b32 v36, v41, v40, s59
    v_perm_b32 v33, v43, v42, s58
    v_perm_b32 v37, v43, v42, s59
    v_perm_b32 v34, v45, v44, s58
    v_perm_b32 v38, v45, v44, s59
    v_perm_b32 v35, v47, v46, s58
    v_perm_b32 v39, v47, v46, s59
    v_mov_b32 v7, 0
    ds_read_b32 v6, v7 offset:28
    s_waitcnt lgkmcnt(0)
    v_readfirstlane_b32 s60, v6
    s_nop 2
    s_cmp_lg_u32 s60, 0
    s_cbranch_scc1 Lgd_63
    s_waitcnt vmcnt(4)
Lgd_63:
    s_add_u32 s57, s56, 1769472
    buffer_load_dword v80, v4, s[36:39], s57 offen nt
    s_add_u32 s57, s56, 1843200
    buffer_load_dword v81, v4, s[36:39], s57 offen nt
    s_add_u32 s57, s56, 1916928
    buffer_load_dword v82, v4, s[36:39], s57 offen nt
    s_add_u32 s57, s56, 1990656
    buffer_load_dword v83, v4, s[36:39], s57 offen nt
    s_add_u32 s57, s56, 1778688
    buffer_load_dword v84, v4, s[36:39], s57 offen nt
    s_add_u32 s57, s56, 1852416
    buffer_load_dword v85, v4, s[36:39], s57 offen nt
    s_add_u32 s57, s56, 1926144
    buffer_load_dword v86, v4, s[36:39], s57 offen nt
    s_add_u32 s57, s56, 1999872
    buffer_load_dword v87, v4, s[36:39], s57 offen nt
    s_waitcnt vmcnt(32)
    v_perm_b32 v40, v49, v48, s58
    v_perm_b32 v44, v49, v48, s59
    v_perm_b32 v41, v51, v50, s58
    v_perm_b32 v45, v51, v50, s59
    v_perm_b32 v42, v53, v52, s58
    v_perm_b32 v46, v53, v52, s59
    v_perm_b32 v43, v55, v54, s58
    v_perm_b32 v47, v55, v54, s59
    v_mov_b32 v7, 0
    ds_read_b32 v6, v7 offset:28
    s_waitcnt lgkmcnt(0)
    v_readfirstlane_b32 s60, v6
    s_nop 2
    s_cmp_lg_u32 s60, 0
    s_cbranch_scc1 Lgd_64
    s_waitcnt vmcnt(4)
Lgd_64:
    s_add_u32 s57, s56, 2064384
    buffer_load_dword v88, v4, s[36:39], s57 offen nt
    s_add_u32 s57, s56, 2138112
    buffer_load_dword v89, v4, s[36:39], s57 offen nt
    s_add_u32 s57, s56, 2211840
    buffer_load_dword v90, v4, s[36:39], s57 offen nt
    s_add_u32 s57, s56, 2285568
    buffer_load_dword v91, v4, s[36:39], s57 offen nt
    s_add_u32 s57, s56, 2073600
    buffer_load_dword v92, v4, s[36:39], s57 offen nt
    s_add_u32 s57, s56, 2147328
    buffer_load_dword v93, v4, s[36:39], s57 offen nt
    s_add_u32 s57, s56, 2221056
    buffer_load_dword v94, v4, s[36:39], s57 offen nt
    s_add_u32 s57, s56, 2294784
    buffer_load_dword v95, v4, s[36:39], s57 offen nt
    s_waitcnt vmcnt(32)
    v_perm_b32 v48, v57, v56, s58
    v_perm_b32 v52, v57, v56, s59
    v_perm_b32 v49, v59, v58, s58
    v_perm_b32 v53, v59, v58, s59
    v_perm_b32 v50, v61, v60, s58
    v_perm_b32 v54, v61, v60, s59
    v_perm_b32 v51, v63, v62, s58
    v_perm_b32 v55, v63, v62, s59
    v_mov_b32 v7, 0
    ds_read_b32 v6, v7 offset:28
    s_waitcnt lgkmcnt(0)
    v_readfirstlane_b32 s60, v6
    s_nop 2
    s_cmp_lg_u32 s60, 0
    s_cbranch_scc1 Lgd_65
    s_waitcnt vmcnt(4)
Lgd_65:
    s_add_u32 s57, s56, 2359296
    buffer_load_dword v96, v4, s[36:39], s57 offen nt
    s_add_u32 s57, s56, 2433024
    buffer_load_dword v97, v4, s[36:39], s57 offen nt
    s_add_u32 s57, s56, 2506752
    buffer_load_dword v98, v4, s[36:39], s57 offen nt
    s_add_u32 s57, s56, 2580480
    buffer_load_dword v99, v4, s[36:39], s57 offen nt
    s_add_u32 s57, s56, 2368512
    buffer_load_dword v100, v4, s[36:39], s57 offen nt
    s_add_u32 s57, s56, 2442240
    buffer_load_dword v101, v4, s[36:39], s57 offen nt
    s_add_u32 s57, s56, 2515968
    buffer_load_dword v102, v4, s[36:39], s57 offen nt
    s_add_u32 s57, s56, 2589696
    buffer_load_dword v103, v4, s[36:39], s57 offen nt
    s_waitcnt vmcnt(32)
    v_perm_b32 v56, v65, v64, s58
    v_perm_b32 v60, v65, v64, s59
    v_perm_b32 v57, v67, v66, s58
    v_perm_b32 v61, v67, v66, s59
    v_perm_b32 v58, v69, v68, s58
    v_perm_b32 v62, v69, v68, s59
    v_perm_b32 v59, v71, v70, s58
    v_perm_b32 v63, v71, v70, s59
    s_waitcnt vmcnt(24)
    v_perm_b32 v64, v73, v72, s58
    v_perm_b32 v68, v73, v72, s59
    v_perm_b32 v65, v75, v74, s58
    v_perm_b32 v69, v75, v74, s59
    v_perm_b32 v66, v77, v76, s58
    v_perm_b32 v70, v77, v76, s59
    v_perm_b32 v67, v79, v78, s58
    v_perm_b32 v71, v79, v78, s59
    s_waitcnt vmcnt(16)
    v_perm_b32 v72, v81, v80, s58
    v_perm_b32 v76, v81, v80, s59
    v_perm_b32 v73, v83, v82, s58
    v_perm_b32 v77, v83, v82, s59
    v_perm_b32 v74, v85, v84, s58
    v_perm_b32 v78, v85, v84, s59
    v_perm_b32 v75, v87, v86, s58
    v_perm_b32 v79, v87, v86, s59
    s_waitcnt vmcnt(8)
    v_perm_b32 v80, v89, v88, s58
    v_perm_b32 v84, v89, v88, s59
    v_perm_b32 v81, v91, v90, s58
    v_perm_b32 v85, v91, v90, s59
    v_perm_b32 v82, v93, v92, s58
    v_perm_b32 v86, v93, v92, s59
    v_perm_b32 v83, v95, v94, s58
    v_perm_b32 v87, v95, v94, s59
    s_waitcnt vmcnt(0)
    v_perm_b32 v88, v97, v96, s58
    v_perm_b32 v92, v97, v96, s59
    v_perm_b32 v89, v99, v98, s58
    v_perm_b32 v93, v99, v98, s59
    v_perm_b32 v90, v101, v100, s58
    v_perm_b32 v94, v101, v100, s59
    v_perm_b32 v91, v103, v102, s58
    v_perm_b32 v95, v103, v102, s59
    s_mul_i32 s57, s55, 576
    v_lshlrev_b32 v5, 4, v3
    v_add_u32 v5, s57, v5
    s_lshl_b32 s57, s53, 7
    v_lshlrev_b32 v6, 3, v1
    v_add_u32 v6, s57, v6
    s_barrier
    ds_read_b128 v[96:99], v5 offset:1280
    ds_read_b128 v[100:103], v5 offset:1344
    ds_read_b128 v[104:107], v5 offset:1408
    ds_read_b128 v[108:111], v5 offset:1472
    ds_read_b128 v[112:115], v5 offset:1536
    ds_read_b128 v[116:119], v5 offset:1600
    ds_read_b128 v[120:123], v5 offset:1664
    ds_read_b128 v[124:127], v5 offset:1728
    ds_read_b128 v[20:23], v5 offset:1792
    s_waitcnt lgkmcnt(8)
    v_mfma_f32_16x16x32_bf16 v[8:11], v[96:99], v[24:27], 0
    v_mfma_f32_16x16x32_bf16 v[12:15], v[96:99], v[28:31], 0
    s_waitcnt lgkmcnt(7)
    v_mfma_f32_16x16x32_bf16 v[8:11], v[100:103], v[32:35], v[8:11]
    v_mfma_f32_16x16x32_bf16 v[12:15], v[100:103], v[36:39], v[12:15]
    s_waitcnt lgkmcnt(6)
    v_mfma_f32_16x16x32_bf16 v[8:11], v[104:107], v[40:43], v[8:11]
    v_mfma_f32_16x16x32_bf16 v[12:15], v[104:107], v[44:47], v[12:15]
    s_waitcnt lgkmcnt(5)
    v_mfma_f32_16x16x32_bf16 v[8:11], v[108:111], v[48:51], v[8:11]
    v_mfma_f32_16x16x32_bf16 v[12:15], v[108:111], v[52:55], v[12:15]
    s_waitcnt lgkmcnt(4)
    v_mfma_f32_16x16x32_bf16 v[8:11], v[112:115], v[56:59], v[8:11]
    v_mfma_f32_16x16x32_bf16 v[12:15], v[112:115], v[60:63], v[12:15]
    s_waitcnt lgkmcnt(3)
    v_mfma_f32_16x16x32_bf16 v[8:11], v[116:119], v[64:67], v[8:11]
    v_mfma_f32_16x16x32_bf16 v[12:15], v[116:119], v[68:71], v[12:15]
    s_waitcnt lgkmcnt(2)
    v_mfma_f32_16x16x32_bf16 v[8:11], v[120:123], v[72:75], v[8:11]
    v_mfma_f32_16x16x32_bf16 v[12:15], v[120:123], v[76:79], v[12:15]
    s_waitcnt lgkmcnt(1)
    v_mfma_f32_16x16x32_bf16 v[8:11], v[124:127], v[80:83], v[8:11]
    v_mfma_f32_16x16x32_bf16 v[12:15], v[124:127], v[84:87], v[12:15]
    s_waitcnt lgkmcnt(0)
    v_mfma_f32_16x16x32_bf16 v[8:11], v[20:23], v[88:91], v[8:11]
    v_mfma_f32_16x16x32_bf16 v[12:15], v[20:23], v[92:95], v[12:15]
    s_nop 6
    v_mov_b32 v16, v8
    v_mov_b32 v17, v12
    s_mov_b64 exec, 0xffff
    ds_write_b64 v6, v[16:17] offset:2560
    s_mov_b64 exec, -1
    s_waitcnt lgkmcnt(0)
    s_barrier
    s_branch L_exit
L_down:
    v_mov_b32 v7, 0
    s_mov_b32 s61, 0x400000
Lw_66:
    ds_read_b32 v6, v7 offset:28
    s_waitcnt lgkmcnt(0)
    v_readfirstlane_b32 s60, v6
    s_nop 2
    s_cmp_ge_u32 s60, 1
    s_cbranch_scc1 Ld_67
    s_sub_u32 s61, s61, 1
    s_cbranch_scc1 L_abort
    s_sleep 1
    s_branch Lw_66
Ld_67:
    s_mov_b32 s36, s24
    s_mov_b32 s37, s25
    s_mov_b32 s38, 5308416
    s_mov_b32 s39, 0x20000
    s_mul_i32 s54, s4, 9
    s_add_u32 s54, s54, s5
    s_sub_u32 s54, s54, 7
    s_mul_i32 s55, s54, 36864
    s_cmp_eq_u32 s53, 4
    s_cbranch_scc1 L_down_half
    s_lshl_b32 s56, s53, 8
    s_add_u32 s55, s55, s56
    v_mul_u32_u24 v4, 1152, v3
    v_lshl_add_u32 v4, v2, 4, v4
    buffer_load_dwordx4 v[32:35], v4, s[36:39], s55 offen nt
    s_add_u32 s55, s55, 4608
    buffer_load_dwordx4 v[36:39], v4, s[36:39], s55 offen nt
    s_add_u32 s55, s55, 4608
    buffer_load_dwordx4 v[40:43], v4, s[36:39], s55 offen nt
    s_add_u32 s55, s55, 4608
    buffer_load_dwordx4 v[44:47], v4, s[36:39], s55 offen nt
    s_add_u32 s55, s55, 4608
    buffer_load_dwordx4 v[48:51], v4, s[36:39], s55 offen nt
    s_add_u32 s55, s55, 4608
    buffer_load_dwordx4 v[52:55], v4, s[36:39], s55 offen nt
    s_add_u32 s55, s55, 4608
    buffer_load_dwordx4 v[56:59], v4, s[36:39], s55 offen nt
    s_add_u32 s55, s55, 4608
    buffer_load_dwordx4 v[60:63], v4, s[36:39], s55 offen nt
    v_lshlrev_b32 v5, 2, v3
    s_mov_b32 s57, 16
    s_branch L_down_go
L_down_half:
    s_add_u32 s55, s55, 1024
    v_lshrrev_b32 v6, 3, v2
    v_lshl_add_u32 v6, v6, 2, v3
    v_mul_u32_u24 v4, 1152, v6
    v_and_b32 v7, 7, v2
    v_lshl_add_u32 v4, v7, 4, v4
    v_lshlrev_b32 v5, 2, v6
    buffer_load_dwordx4 v[32:35], v4, s[36:39], s55 offen nt
    s_add_u32 s55, s55, 9216
    buffer_load_dwordx4 v[36:39], v4, s[36:39], s55 offen nt
    s_add_u32 s55, s55, 9216
    buffer_load_dwordx4 v[40:43], v4, s[36:39], s55 offen nt
    s_add_u32 s55, s55, 9216
    buffer_load_dwordx4 v[44:47], v4, s[36:39], s55 offen nt
    s_mov_b32 s57, 32
L_down_go:
    v_and_b32 v6, 1, v2
    v_lshlrev_b32 v6, 4, v6
    v_mov_b32 v7, 0xffff
    v_lshlrev_b32 v7, v6, v7
    v_bfe_u32 v6, v2, 1, 2
    v_cmp_eq_u32 vcc, 0, v6
    s_nop 1
    v_cndmask_b32 v8, 0, v7, vcc
    v_cmp_eq_u32 vcc, 1, v6
    s_nop 1
    v_cndmask_b32 v9, 0, v7, vcc
    v_cmp_eq_u32 vcc, 2, v6
    s_nop 1
    v_cndmask_b32 v10, 0, v7, vcc
    v_cmp_eq_u32 vcc, 3, v6
    s_nop 1
    v_cndmask_b32 v11, 0, v7, vcc
    v_and_b32 v12, 7, v2
    v_lshl_add_u32 v12, v3, 3, v12
    v_lshlrev_b32 v12, 5, v12
    v_lshrrev_b32 v6, 3, v2
    v_lshl_add_u32 v12, v6, 4, v12
    v_mov_b32 v86, s6
    v_mov_b32 v87, s7
    v_mov_b32 v104, v5
    v_add_u32 v5, s57, v5
    v_mov_b32 v105, v5
    v_add_u32 v5, s57, v5
    v_mov_b32 v106, v5
    v_add_u32 v5, s57, v5
    v_mov_b32 v107, v5
    v_add_u32 v5, s57, v5
    v_mov_b32 v108, v5
    v_add_u32 v5, s57, v5
    v_mov_b32 v109, v5
    v_add_u32 v5, s57, v5
    v_mov_b32 v110, v5
    v_add_u32 v5, s57, v5
    v_mov_b32 v111, v5
    s_mul_i32 s59, s54, 4608
    s_add_u32 s59, s59, 1441792
    v_and_b32 v6, 31, v1
    v_lshlrev_b32 v13, 2, v6
    s_barrier
    s_barrier
    ds_read_b32 v16, v13 offset:2560
    ds_read_b32 v17, v13 offset:2688
    ds_read_b32 v18, v13 offset:2816
    ds_read_b32 v19, v13 offset:2944
    s_waitcnt lgkmcnt(0)
    v_add_f32 v16, v16, v17
    v_add_f32 v18, v18, v19
    v_cvt_pk_bf16_f32 v16, v16, v16
    v_cvt_pk_bf16_f32 v18, v18, v18
    v_lshlrev_b32 v16, 16, v16
    v_lshlrev_b32 v18, 16, v18
    s_mov_b32 s60, 0x3d372713
    s_mov_b32 s61, 0xc0135761
    v_mul_f32 v17, v16, v16
    v_mul_f32 v17, v17, v16
    v_fma_f32 v17, v17, s60, v16
    v_mul_f32 v17, s61, v17
    v_exp_f32 v17, v17
    s_nop 0
    v_add_f32 v17, 1.0, v17
    v_rcp_f32 v17, v17
    s_nop 0
    v_mul_f32 v16, v16, v17
    v_cvt_pk_bf16_f32 v16, v16, v16
    v_lshlrev_b32 v16, 16, v16
    v_mul_f32 v16, v16, v18
    v_cvt_pk_bf16_f32 v16, v16, v16
    ds_bpermute_b32 v64, v104, v16
    ds_bpermute_b32 v65, v105, v16
    ds_bpermute_b32 v66, v106, v16
    ds_bpermute_b32 v67, v107, v16
    ds_bpermute_b32 v68, v108, v16
    ds_bpermute_b32 v69, v109, v16
    ds_bpermute_b32 v70, v110, v16
    ds_bpermute_b32 v71, v111, v16
    s_waitcnt vmcnt(0) lgkmcnt(0)
    s_cmp_eq_u32 s53, 4
    s_cbranch_scc1 L_down_half2
    v_and_b32 v76, v64, v8
    v_and_b32 v77, v64, v9
    v_and_b32 v78, v64, v10
    v_and_b32 v79, v64, v11
    v_and_b32 v80, v65, v8
    v_and_b32 v81, v65, v9
    v_and_b32 v82, v65, v10
    v_and_b32 v83, v65, v11
    v_mfma_f32_16x16x32_bf16 v[72:75], v[32:35], v[76:79], 0
    v_and_b32 v76, v66, v8
    v_and_b32 v77, v66, v9
    v_and_b32 v78, v66, v10
    v_and_b32 v79, v66, v11
    v_mfma_f32_16x16x32_bf16 v[72:75], v[36:39], v[80:83], v[72:75]
    v_and_b32 v80, v67, v8
    v_and_b32 v81, v67, v9
    v_and_b32 v82, v67, v10
    v_and_b32 v83, v67, v11
    v_mfma_f32_16x16x32_bf16 v[72:75], v[40:43], v[76:79], v[72:75]
    v_and_b32 v76, v68, v8
    v_and_b32 v77, v68, v9
    v_and_b32 v78, v68, v10
    v_and_b32 v79, v68, v11
    v_mfma_f32_16x16x32_bf16 v[72:75], v[44:47], v[80:83], v[72:75]
    v_and_b32 v80, v69, v8
    v_and_b32 v81, v69, v9
    v_and_b32 v82, v69, v10
    v_and_b32 v83, v69, v11
    v_mfma_f32_16x16x32_bf16 v[72:75], v[48:51], v[76:79], v[72:75]
    v_and_b32 v76, v70, v8
    v_and_b32 v77, v70, v9
    v_and_b32 v78, v70, v10
    v_and_b32 v79, v70, v11
    v_mfma_f32_16x16x32_bf16 v[72:75], v[52:55], v[80:83], v[72:75]
    v_and_b32 v80, v71, v8
    v_and_b32 v81, v71, v9
    v_and_b32 v82, v71, v10
    v_and_b32 v83, v71, v11
    v_mfma_f32_16x16x32_bf16 v[72:75], v[56:59], v[76:79], v[72:75]
    s_nop 0
    v_mfma_f32_16x16x32_bf16 v[72:75], v[60:63], v[80:83], v[72:75]
    s_nop 7
    v_mov_b32 v84, v72
    v_mov_b32 v85, v73
    s_nop 0
    v_mov_b32_dpp v84, v74 row_shr:8 row_mask:0xf bank_mask:0xc
    v_mov_b32_dpp v85, v75 row_shr:8 row_mask:0xf bank_mask:0xc
    s_lshl_b32 s60, s53, 10
    s_add_u32 s59, s59, s60
    buffer_store_dwordx4 v[84:87], v12, s[44:47], s59 offen sc1
    s_branch L_exit
L_down_half2:
    v_and_b32 v76, v64, v8
    v_and_b32 v77, v64, v9
    v_and_b32 v78, v64, v10
    v_and_b32 v79, v64, v11
    v_and_b32 v80, v65, v8
    v_and_b32 v81, v65, v9
    v_and_b32 v82, v65, v10
    v_and_b32 v83, v65, v11
    v_mfma_f32_16x16x32_bf16 v[72:75], v[32:35], v[76:79], 0
    v_and_b32 v76, v66, v8
    v_and_b32 v77, v66, v9
    v_and_b32 v78, v66, v10
    v_and_b32 v79, v66, v11
    v_mfma_f32_16x16x32_bf16 v[72:75], v[36:39], v[80:83], v[72:75]
    v_and_b32 v80, v67, v8
    v_and_b32 v81, v67, v9
    v_and_b32 v82, v67, v10
    v_and_b32 v83, v67, v11
    v_mfma_f32_16x16x32_bf16 v[72:75], v[40:43], v[76:79], v[72:75]
    s_nop 0
    v_mfma_f32_16x16x32_bf16 v[72:75], v[44:47], v[80:83], v[72:75]
    s_nop 7
    v_mov_b32 v88, v72
    v_mov_b32 v89, v73
    v_mov_b32 v90, v74
    v_mov_b32 v91, v75
    v_permlane32_swap_b32 v72, v88
    v_permlane32_swap_b32 v73, v89
    v_permlane32_swap_b32 v74, v90
    v_permlane32_swap_b32 v75, v91
    v_add_f32_dpp v72, v88, v72 row_shl:8 row_mask:0xf bank_mask:0xf
    v_add_f32_dpp v73, v89, v73 row_shl:8 row_mask:0xf bank_mask:0xf
    v_add_f32_dpp v74, v90, v74 row_shl:8 row_mask:0xf bank_mask:0xf
    v_add_f32_dpp v75, v91, v75 row_shl:8 row_mask:0xf bank_mask:0xf
    v_mov_b32 v84, v72
    v_mov_b32 v85, v73
    s_nop 0
    v_mov_b32_dpp v84, v74 row_shr:8 row_mask:0xf bank_mask:0xc
    v_mov_b32_dpp v85, v75 row_shr:8 row_mask:0xf bank_mask:0xc
    s_add_u32 s59, s59, 4096
    s_mov_b64 s[62:63], exec
    s_mov_b64 exec, 0xffffffff
    buffer_store_dwordx4 v[84:87], v12, s[44:47], s59 offen sc1
    s_mov_b64 exec, s[62:63]
    s_branch L_exit
L_commF:
    s_setprio 3
    v_lshlrev_b32 v4, 4, v1
    v_and_b32 v5, 31, v1
    v_lshlrev_b32 v5, 4, v5
    s_mov_b32 s56, 135680
    s_mov_b32 s57, 140288
    s_add_u32 s58, s56, 4096
    s_add_u32 s59, s57, 4096
    s_and_b32 s52, s2, 7
    s_mul_i32 s52, s52, 5120
    s_add_u32 s52, s52, 163840
    s_add_u32 s53, s52, 4096
    v_cmp_gt_u32 s[54:55], 32, v1
    v_mov_b32 v7, 0
    s_mov_b32 s61, 0x400000
Lw_68:
    ds_read_b32 v6, v7 offset:28
    s_waitcnt lgkmcnt(0)
    v_readfirstlane_b32 s60, v6
    s_nop 2
    s_cmp_ge_u32 s60, 1
    s_cbranch_scc1 Ld_69
    s_sub_u32 s61, s61, 1
    s_cbranch_scc1 L_abort
    s_sleep 1
    s_branch Lw_68
Ld_69:
    s_mov_b32 s64, 0x8000
Lp_70:
    buffer_load_dwordx4 v[32:35], v4, s[44:47], s56 offen offset:0 sc1
    buffer_load_dwordx4 v[36:39], v4, s[44:47], s56 offen offset:1024 sc1
    buffer_load_dwordx4 v[40:43], v4, s[44:47], s56 offen offset:2048 sc1
    buffer_load_dwordx4 v[44:47], v4, s[44:47], s56 offen offset:3072 sc1
    buffer_load_dwordx4 v[48:51], v5, s[44:47], s58 offen sc1
    buffer_load_dwordx4 v[52:55], v4, s[44:47], s57 offen offset:0 sc1
    buffer_load_dwordx4 v[56:59], v4, s[44:47], s57 offen offset:1024 sc1
    buffer_load_dwordx4 v[60:63], v4, s[44:47], s57 offen offset:2048 sc1
    buffer_load_dwordx4 v[64:67], v4, s[44:47], s57 offen offset:3072 sc1
    buffer_load_dwordx4 v[68:71], v5, s[44:47], s59 offen sc1
    s_waitcnt vmcnt(0)
    v_cmp_ne_u64 s[66:67], s[6:7], v[34:35]
    v_cmp_ne_u64 s[68:69], s[6:7], v[38:39]
    v_cmp_ne_u64 s[70:71], s[6:7], v[42:43]
    v_cmp_ne_u64 s[72:73], s[6:7], v[46:47]
    v_cmp_ne_u64 vcc, s[6:7], v[50:51]
    s_nop 2
    s_or_b64 vcc, vcc, s[66:67]
    s_or_b64 vcc, vcc, s[68:69]
    s_or_b64 vcc, vcc, s[70:71]
    s_or_b64 vcc, vcc, s[72:73]
    s_mov_b64 s[62:63], vcc
    v_cmp_ne_u64 s[66:67], s[6:7], v[54:55]
    v_cmp_ne_u64 s[68:69], s[6:7], v[58:59]
    v_cmp_ne_u64 s[70:71], s[6:7], v[62:63]
    v_cmp_ne_u64 s[72:73], s[6:7], v[66:67]
    v_cmp_ne_u64 vcc, s[6:7], v[70:71]
    s_nop 2
    s_or_b64 vcc, vcc, s[66:67]
    s_or_b64 vcc, vcc, s[68:69]
    s_or_b64 vcc, vcc, s[70:71]
    s_or_b64 vcc, vcc, s[72:73]
    s_or_b64 vcc, vcc, s[62:63]
    s_sub_u32 s64, s64, 1
    s_cbranch_scc1 L_abort
    s_cbranch_vccnz Lp_70
    v_add_f32 v52, 1.0, v52
    v_add_f32 v53, 1.0, v53
    v_add_f32 v56, 1.0, v56
    v_add_f32 v57, 1.0, v57
    v_add_f32 v60, 1.0, v60
    v_add_f32 v61, 1.0, v61
    v_add_f32 v64, 1.0, v64
    v_add_f32 v65, 1.0, v65
    v_add_f32 v68, 1.0, v68
    v_add_f32 v69, 1.0, v69
    v_cvt_pk_bf16_f32 v52, v52, v52
    v_cvt_pk_bf16_f32 v53, v53, v53
    v_cvt_pk_bf16_f32 v56, v56, v56
    v_cvt_pk_bf16_f32 v57, v57, v57
    v_cvt_pk_bf16_f32 v60, v60, v60
    v_cvt_pk_bf16_f32 v61, v61, v61
    v_cvt_pk_bf16_f32 v64, v64, v64
    v_cvt_pk_bf16_f32 v65, v65, v65
    v_cvt_pk_bf16_f32 v68, v68, v68
    v_cvt_pk_bf16_f32 v69, v69, v69
    v_lshlrev_b32 v52, 16, v52
    v_lshlrev_b32 v53, 16, v53
    v_lshlrev_b32 v56, 16, v56
    v_lshlrev_b32 v57, 16, v57
    v_lshlrev_b32 v60, 16, v60
    v_lshlrev_b32 v61, 16, v61
    v_lshlrev_b32 v64, 16, v64
    v_lshlrev_b32 v65, 16, v65
    v_lshlrev_b32 v68, 16, v68
    v_lshlrev_b32 v69, 16, v69
    v_lshlrev_b32 v6, 2, v1
    s_mov_b32 s64, 0x8000
Lp_72:
    buffer_load_dwordx4 v[72:75], v4, s[44:47], s52 offen offset:0 sc1
    buffer_load_dwordx4 v[76:79], v4, s[44:47], s52 offen offset:1024 sc1
    buffer_load_dwordx4 v[80:83], v4, s[44:47], s52 offen offset:2048 sc1
    buffer_load_dwordx4 v[84:87], v4, s[44:47], s52 offen offset:3072 sc1
    buffer_load_dwordx4 v[88:91], v5, s[44:47], s53 offen sc1
    s_waitcnt vmcnt(0)
    v_cmp_ne_u64 s[66:67], s[6:7], v[74:75]
    v_cmp_ne_u64 s[68:69], s[6:7], v[78:79]
    v_cmp_ne_u64 s[70:71], s[6:7], v[82:83]
    v_cmp_ne_u64 s[72:73], s[6:7], v[86:87]
    v_cmp_ne_u64 vcc, s[6:7], v[90:91]
    s_nop 2
    s_or_b64 vcc, vcc, s[66:67]
    s_or_b64 vcc, vcc, s[68:69]
    s_or_b64 vcc, vcc, s[70:71]
    s_or_b64 vcc, vcc, s[72:73]
    s_sub_u32 s64, s64, 1
    s_cbranch_scc1 L_abort
    s_cbranch_vccnz Lp_72
    v_cndmask_b32 v88, 0, v88, s[54:55]
    v_cndmask_b32 v89, 0, v89, s[54:55]
    v_pk_add_f32 v[112:113], v[72:73], v[76:77]
    v_pk_add_f32 v[114:115], v[80:81], v[84:85]
    v_pk_add_f32 v[112:113], v[112:113], v[88:89]
    v_pk_add_f32 v[112:113], v[112:113], v[114:115]
    v_add_f32 v112, v112, v113
    s_nop 1
    v_add_f32_dpp v112, v112, v112 quad_perm:[1,0,3,2] row_mask:0xf bank_mask:0xf
    s_nop 1
    v_add_f32_dpp v112, v112, v112 quad_perm:[2,3,0,1] row_mask:0xf bank_mask:0xf
    s_nop 1
    v_add_f32_dpp v112, v112, v112 row_half_mirror row_mask:0xf bank_mask:0xf
    s_nop 1
    v_add_f32_dpp v112, v112, v112 row_mirror row_mask:0xf bank_mask:0xf
    v_mov_b32 v113, v112
    s_nop 1
    v_permlane16_swap_b32 v112, v113
    v_add_f32 v112, v112, v113
    v_mov_b32 v113, v112
    s_nop 1
    v_permlane32_swap_b32 v112, v113
    v_add_f32 v112, v112, v113
    s_mov_b32 s60, 0x3ae38e39
    v_mul_f32 v112, s60, v112
    v_mov_b32 v113, v112
    v_pk_add_f32 v[74:75], v[72:73], v[112:113] neg_lo:[0,1] neg_hi:[0,1]
    v_pk_add_f32 v[78:79], v[76:77], v[112:113] neg_lo:[0,1] neg_hi:[0,1]
    v_pk_add_f32 v[82:83], v[80:81], v[112:113] neg_lo:[0,1] neg_hi:[0,1]
    v_pk_add_f32 v[86:87], v[84:85], v[112:113] neg_lo:[0,1] neg_hi:[0,1]
    v_pk_add_f32 v[90:91], v[88:89], v[112:113] neg_lo:[0,1] neg_hi:[0,1]
    v_cndmask_b32 v90, 0, v90, s[54:55]
    v_cndmask_b32 v91, 0, v91, s[54:55]
    v_pk_mul_f32 v[114:115], v[74:75], v[74:75]
    v_pk_fma_f32 v[114:115], v[78:79], v[78:79], v[114:115]
    v_pk_fma_f32 v[114:115], v[82:83], v[82:83], v[114:115]
    v_pk_fma_f32 v[114:115], v[86:87], v[86:87], v[114:115]
    v_pk_fma_f32 v[114:115], v[90:91], v[90:91], v[114:115]
    v_add_f32 v114, v114, v115
    s_nop 1
    v_add_f32_dpp v114, v114, v114 quad_perm:[1,0,3,2] row_mask:0xf bank_mask:0xf
    s_nop 1
    v_add_f32_dpp v114, v114, v114 quad_perm:[2,3,0,1] row_mask:0xf bank_mask:0xf
    s_nop 1
    v_add_f32_dpp v114, v114, v114 row_half_mirror row_mask:0xf bank_mask:0xf
    s_nop 1
    v_add_f32_dpp v114, v114, v114 row_mirror row_mask:0xf bank_mask:0xf
    v_mov_b32 v115, v114
    s_nop 1
    v_permlane16_swap_b32 v114, v115
    v_add_f32 v114, v114, v115
    v_mov_b32 v115, v114
    s_nop 1
    v_permlane32_swap_b32 v114, v115
    v_add_f32 v114, v114, v115
    v_mul_f32 v114, s60, v114
    v_cvt_pk_bf16_f32 v114, v114, v114
    v_lshlrev_b32 v114, 16, v114
    v_add_f32 v114, 0x3727c5ac, v114
    v_cvt_pk_bf16_f32 v114, v114, v114
    v_lshlrev_b32 v114, 16, v114
    v_sqrt_f32 v114, v114
    s_nop 0
    v_cvt_pk_bf16_f32 v114, v114, v114
    v_lshlrev_b32 v114, 16, v114
    v_rcp_f32 v114, v114
    v_cvt_pk_bf16_f32 v112, v112, v112
    v_lshlrev_b32 v112, 16, v112
    v_mov_b32 v113, v112
    v_mov_b32 v115, v114
    s_mov_b32 s61, 0xffff0000
    v_pk_add_f32 v[72:73], v[72:73], v[112:113] neg_lo:[0,1] neg_hi:[0,1]
    v_pk_add_f32 v[76:77], v[76:77], v[112:113] neg_lo:[0,1] neg_hi:[0,1]
    v_pk_add_f32 v[80:81], v[80:81], v[112:113] neg_lo:[0,1] neg_hi:[0,1]
    v_pk_add_f32 v[84:85], v[84:85], v[112:113] neg_lo:[0,1] neg_hi:[0,1]
    v_pk_add_f32 v[88:89], v[88:89], v[112:113] neg_lo:[0,1] neg_hi:[0,1]
    v_cvt_pk_bf16_f32 v74, v72, v73
    v_cvt_pk_bf16_f32 v78, v76, v77
    v_cvt_pk_bf16_f32 v82, v80, v81
    v_cvt_pk_bf16_f32 v86, v84, v85
    v_cvt_pk_bf16_f32 v90, v88, v89
    v_lshlrev_b32 v72, 16, v74
    v_and_b32 v73, s61, v74
    v_lshlrev_b32 v76, 16, v78
    v_and_b32 v77, s61, v78
    v_lshlrev_b32 v80, 16, v82
    v_and_b32 v81, s61, v82
    v_lshlrev_b32 v84, 16, v86
    v_and_b32 v85, s61, v86
    v_lshlrev_b32 v88, 16, v90
    v_and_b32 v89, s61, v90
    v_pk_mul_f32 v[72:73], v[72:73], v[114:115]
    v_pk_mul_f32 v[76:77], v[76:77], v[114:115]
    v_pk_mul_f32 v[80:81], v[80:81], v[114:115]
    v_pk_mul_f32 v[84:85], v[84:85], v[114:115]
    v_pk_mul_f32 v[88:89], v[88:89], v[114:115]
    v_cvt_pk_bf16_f32 v74, v72, v73
    v_cvt_pk_bf16_f32 v78, v76, v77
    v_cvt_pk_bf16_f32 v82, v80, v81
    v_cvt_pk_bf16_f32 v86, v84, v85
    v_cvt_pk_bf16_f32 v90, v88, v89
    v_lshlrev_b32 v72, 16, v74
    v_and_b32 v73, s61, v74
    v_lshlrev_b32 v76, 16, v78
    v_and_b32 v77, s61, v78
    v_lshlrev_b32 v80, 16, v82
    v_and_b32 v81, s61, v82
    v_lshlrev_b32 v84, 16, v86
    v_and_b32 v85, s61, v86
    v_lshlrev_b32 v88, 16, v90
    v_and_b32 v89, s61, v90
    v_pk_mul_f32 v[72:73], v[72:73], v[52:53]
    v_pk_mul_f32 v[76:77], v[76:77], v[56:57]
    v_pk_mul_f32 v[80:81], v[80:81], v[60:61]
    v_pk_mul_f32 v[84:85], v[84:85], v[64:65]
    v_pk_mul_f32 v[88:89], v[88:89], v[68:69]
    v_cvt_pk_bf16_f32 v74, v72, v73
    v_cvt_pk_bf16_f32 v78, v76, v77
    v_cvt_pk_bf16_f32 v82, v80, v81
    v_cvt_pk_bf16_f32 v86, v84, v85
    v_cvt_pk_bf16_f32 v90, v88, v89
    v_lshlrev_b32 v72, 16, v74
    v_and_b32 v73, s61, v74
    v_lshlrev_b32 v76, 16, v78
    v_and_b32 v77, s61, v78
    v_lshlrev_b32 v80, 16, v82
    v_and_b32 v81, s61, v82
    v_lshlrev_b32 v84, 16, v86
    v_and_b32 v85, s61, v86
    v_lshlrev_b32 v88, 16, v90
    v_and_b32 v89, s61, v90
    v_pk_add_f32 v[72:73], v[72:73], v[32:33]
    v_pk_add_f32 v[76:77], v[76:77], v[36:37]
    v_pk_add_f32 v[80:81], v[80:81], v[40:41]
    v_pk_add_f32 v[84:85], v[84:85], v[44:45]
    v_pk_add_f32 v[88:89], v[88:89], v[48:49]
    v_cvt_pk_bf16_f32 v72, v72, v73
    v_cvt_pk_bf16_f32 v76, v76, v77
    v_cvt_pk_bf16_f32 v80, v80, v81
    v_cvt_pk_bf16_f32 v84, v84, v85
    v_cvt_pk_bf16_f32 v88, v88, v89
    ds_write_b32 v6, v72 offset:1280
    ds_write_b32 v6, v76 offset:1536
    ds_write_b32 v6, v80 offset:1792
    ds_write_b32 v6, v84 offset:2048
    s_mov_b64 exec, 0xffffffff
    ds_write_b32 v6, v88 offset:2304
    s_mov_b64 exec, -1
    s_waitcnt lgkmcnt(0)
    s_barrier
    s_branch L_exit
L_abort:
    s_mov_b64 exec, -1
L_exit:
L_end:
    s_endpgm
L_codeend:

.section .rodata,"a"
.p2align 6
.amdhsa_kernel adaLN_cond__sliding_block_cached__geglu_ffn__decode_kernel
  .amdhsa_next_free_vgpr 128
  .amdhsa_next_free_sgpr 102
  .amdhsa_accum_offset 128
  .amdhsa_group_segment_fixed_size 0
  .amdhsa_kernarg_size 112
  .amdhsa_user_sgpr_count 2
  .amdhsa_user_sgpr_kernarg_segment_ptr 1
  .amdhsa_system_sgpr_workgroup_id_x 1
.end_amdhsa_kernel
```
